```python
import torch

def _softmax(x, axis=-1):
    return torch.softmax(x, dim=axis)
def _gelu(x):
    return torch.nn.functional.gelu(x, approximate="tanh")
def _silu(x):
    return torch.nn.functional.silu(x)
def _sigmoid(x):
    return torch.sigmoid(x)
def _layernorm(x, axis=-1, eps=1e-5):
    m = x.mean(dim=axis, keepdim=True)
    v = x.var(dim=axis, keepdim=True, unbiased=False)
    return (x - m) / torch.sqrt(v + eps)
def _scatter_add(tgt, idx, src, axis=0):
    return tgt.clone().index_add_(axis, idx, src)
def _segment_sum(src, seg, n):
    out = torch.zeros((n,) + src.shape[1:], dtype=src.dtype)
    return out.index_add_(0, seg, src)
def _pad(x, pw):
    flat = tuple(v for pair in reversed(pw) for v in pair)
    return torch.nn.functional.pad(x, flat)

kernel_name = 'recurrent_scan__mha_block_cached__glu_gated_bilinear__decode'

def setup_inputs():

    _w = (lambda a: (lambda t: t.to(torch.bfloat16) if t.is_floating_point() else t)(torch.as_tensor(a)))
    def _A_setup():
        B, Sq, D = 4, 1, 448
        H, Sk, Dh = 16, 4096, 256
        return {
            "x": _w((lambda *s: torch.randn(*s, dtype=torch.bfloat16) * 0.2)(B, Sq, D)),
            "k_cache": _w((lambda *s: torch.randn(*s, dtype=torch.bfloat16) * 1.6)(B, H, Sk, Dh)),
            "v_cache": _w((lambda *s: torch.randn(*s, dtype=torch.bfloat16) * 1.6)(B, H, Sk, Dh)),
            "wq": _w((lambda *s: torch.randn(*s, dtype=torch.bfloat16) * 1.6)(D, H * Dh) * (D ** -0.5)),
            "wo": _w((lambda *s: torch.randn(*s, dtype=torch.bfloat16) * 1.6)(H * Dh, D) * ((H * Dh) ** -0.5)),
        }
    _A_in = _A_setup()

    def _B_setup():
        B, S, D, F = 4, 1, 448, 1792
        return {
            "x": _w((lambda *s: torch.randn(*s, dtype=torch.bfloat16) * 0.2)(B, S, D)),
            "w_gate": _w((lambda *s: torch.randn(*s, dtype=torch.bfloat16) * 0.8)(D, F) * (D ** -0.5)),
            "w_up": _w((lambda *s: torch.randn(*s, dtype=torch.bfloat16) * 0.8)(D, F) * (D ** -0.5)),
            "w_down": _w((lambda *s: torch.randn(*s, dtype=torch.bfloat16) * 0.8)(F, D) * (F ** -0.5)),
        }
    _B_in = _B_setup()

    return {
        "A_x": _A_in["x"],
        "A_k_cache": _A_in["k_cache"],
        "A_v_cache": _A_in["v_cache"],
        "A_wq": _A_in["wq"],
        "A_wo": _A_in["wo"],
        "B_x": _B_in["x"],
        "B_w_gate": _B_in["w_gate"],
        "B_w_up": _B_in["w_up"],
        "B_w_down": _B_in["w_down"],
    }

def reference(A_x, A_k_cache, A_v_cache, A_wq, A_wo, B_x, B_w_gate, B_w_up, B_w_down):
    def _A_ref(x, k_cache, v_cache, wq, wo):
        B, Sq, D = x.shape
        H, Dh = 16, 256
        q = (lambda x, *d: x.permute(*d))((x @ wq).reshape(B, Sq, H, Dh), 0, 2, 1, 3)
        scores = torch.einsum("bhqd,bhkd->bhqk", q, k_cache) * (Dh ** -0.5)
        p = _softmax(scores, axis=-1)
        o = torch.einsum("bhqk,bhkd->bhqd", p, v_cache)
        return (lambda x, *d: x.permute(*d))(o, 0, 2, 1, 3).reshape(B, Sq, H * Dh) @ wo

    def _B_ref(x, w_gate, w_up, w_down):
        g = torch.einsum("bsd,df->bsf", x, w_gate)
        u = torch.einsum("bsd,df->bsf", x, w_up)
        h = g * u
        return torch.einsum("bsf,fd->bsd", h, w_down)

    x = A_x
    xn = _layernorm(x, axis=-1)
    s = _A_ref(xn, A_k_cache, A_v_cache, A_wq, A_wo)
    g = _silu(_B_ref(xn, B_w_gate, B_w_up, B_w_down))
    return x + s * g
```

```asm
; @launch grid=(256,1,1) block=(768,1,1) lds=33920
.amdgcn_target "amdgcn-amd-amdhsa--gfx950"
.text
.globl recurrent_scan__mha_block_cached__glu_gated_bilinear__decode_kernel
.p2align 8
.type recurrent_scan__mha_block_cached__glu_gated_bilinear__decode_kernel,@function
recurrent_scan__mha_block_cached__glu_gated_bilinear__decode_kernel:
    s_cmp_ge_u32 s2, 256
    s_cbranch_scc1 L_end
    s_load_dwordx8 s[4:11], s[0:1], 0
    s_load_dwordx8 s[20:27], s[0:1], 64
    s_load_dwordx2 s[12:13], s[0:1], 32
    s_load_dwordx4 s[16:19], s[0:1], 48
    v_lshrrev_b32 v1, 6, v0
    v_and_b32 v2, 15, v0
    v_readfirstlane_b32 s31, v1
    v_bfe_u32 v3, v0, 4, 2
    s_lshr_b32 s28, s2, 6
    s_and_b32 s15, s2, 63
    s_and_b32 s29, s2, 7
    s_lshl_b32 s29, s29, 1
    s_bfe_u32 s3, s2, 0x10003
    s_or_b32 s29, s29, s3
    s_bfe_u32 s30, s2, 0x20004
    s_lshl_b32 s14, s28, 4
    s_add_u32 s14, s14, s29
    s_lshl_b32 s59, s14, 2
    s_add_u32 s59, s59, s30
    s_mov_b32 s35, 0x20000
    s_mov_b32 s39, 0x20000
    s_mov_b32 s43, 0x20000
    s_mov_b32 s47, 0x20000
    s_cmp_lt_u32 s31, 8
    s_cbranch_scc1 L_helper
    s_sub_u32 s63, s31, 8
    s_lshl_b32 s3, s63, 12
    v_lshlrev_b32 v36, 9, v3
    v_lshlrev_b32 v1, 4, v2
    v_add3_u32 v36, v36, v1, s3
    v_add_u32 v37, 16384, v36
    s_mov_b32 s64, 0
    s_mov_b32 s65, 32768
    s_mov_b32 s66, 65536
    s_mov_b32 s67, 98304
    s_lshl_b32 s3, s59, 19
    s_waitcnt lgkmcnt(0)
    s_add_u32 s32, s6, s3
    s_addc_u32 s33, s7, 0
    s_mov_b32 s34, 131072
    s_add_u32 s56, s8, s3
    s_addc_u32 s57, s9, 0
    buffer_load_dwordx4 v[40:43], v36, s[32:35], s64 offen nt
    buffer_load_dwordx4 v[44:47], v36, s[32:35], s64 offen offset:256 nt
    buffer_load_dwordx4 v[48:51], v36, s[32:35], s64 offen offset:2048 nt
    buffer_load_dwordx4 v[52:55], v36, s[32:35], s64 offen offset:2304 nt
    s_barrier
    buffer_load_dwordx4 v[56:59], v37, s[32:35], s64 offen nt
    buffer_load_dwordx4 v[60:63], v37, s[32:35], s64 offen offset:256 nt
    buffer_load_dwordx4 v[64:67], v37, s[32:35], s64 offen offset:2048 nt
    s_waitcnt vmcnt(6)
    buffer_load_dwordx4 v[68:71], v37, s[32:35], s64 offen offset:2304 nt
    s_waitcnt vmcnt(6)
    buffer_load_dwordx4 v[72:75], v36, s[32:35], s65 offen nt
    s_waitcnt vmcnt(6)
    buffer_load_dwordx4 v[76:79], v36, s[32:35], s65 offen offset:256 nt
    s_waitcnt vmcnt(6)
    buffer_load_dwordx4 v[80:83], v36, s[32:35], s65 offen offset:2048 nt
    s_waitcnt vmcnt(6)
    buffer_load_dwordx4 v[84:87], v36, s[32:35], s65 offen offset:2304 nt
    s_waitcnt vmcnt(6)
    buffer_load_dwordx4 v[88:91], v37, s[32:35], s65 offen nt
    s_waitcnt vmcnt(6)
    buffer_load_dwordx4 v[92:95], v37, s[32:35], s65 offen offset:256 nt
    s_waitcnt vmcnt(6)
    buffer_load_dwordx4 v[96:99], v37, s[32:35], s65 offen offset:2048 nt
    s_waitcnt vmcnt(6)
    buffer_load_dwordx4 v[100:103], v37, s[32:35], s65 offen offset:2304 nt
    s_waitcnt vmcnt(6)
    buffer_load_dwordx4 v[104:107], v36, s[32:35], s66 offen nt
    s_waitcnt vmcnt(6)
    buffer_load_dwordx4 v[108:111], v36, s[32:35], s66 offen offset:256 nt
    s_waitcnt vmcnt(6)
    buffer_load_dwordx4 v[112:115], v36, s[32:35], s66 offen offset:2048 nt
    s_waitcnt vmcnt(6)
    buffer_load_dwordx4 v[116:119], v36, s[32:35], s66 offen offset:2304 nt
    s_waitcnt vmcnt(6)
    buffer_load_dwordx4 v[120:123], v37, s[32:35], s66 offen nt
    s_waitcnt vmcnt(6)
    buffer_load_dwordx4 v[124:127], v37, s[32:35], s66 offen offset:256 nt
    s_waitcnt vmcnt(6)
    buffer_load_dwordx4 v[128:131], v37, s[32:35], s66 offen offset:2048 nt
    s_waitcnt vmcnt(6)
    buffer_load_dwordx4 v[132:135], v37, s[32:35], s66 offen offset:2304 nt
    s_waitcnt vmcnt(6)
    buffer_load_dwordx4 v[136:139], v36, s[32:35], s67 offen nt
    s_waitcnt vmcnt(6)
    buffer_load_dwordx4 v[140:143], v36, s[32:35], s67 offen offset:256 nt
    s_waitcnt vmcnt(6)
    buffer_load_dwordx4 v[144:147], v36, s[32:35], s67 offen offset:2048 nt
    s_waitcnt vmcnt(6)
    buffer_load_dwordx4 v[148:151], v36, s[32:35], s67 offen offset:2304 nt
    s_waitcnt vmcnt(6)
    buffer_load_dwordx4 v[152:155], v37, s[32:35], s67 offen nt
    s_waitcnt vmcnt(6)
    buffer_load_dwordx4 v[156:159], v37, s[32:35], s67 offen offset:256 nt
    s_waitcnt vmcnt(6)
    buffer_load_dwordx4 v[160:163], v37, s[32:35], s67 offen offset:2048 nt
    s_waitcnt vmcnt(6)
    buffer_load_dwordx4 v[164:167], v37, s[32:35], s67 offen offset:2304 nt
    s_add_u32 s32, s32, 131072
    s_addc_u32 s33, s33, 0
    v_and_b32 v8, 1, v2
    v_lshlrev_b32 v8, 4, v8
    v_mov_b32 v9, 0xffff
    v_lshlrev_b32 v8, v8, v9
    v_bfe_u32 v9, v2, 1, 2
    v_cmp_eq_u32 vcc, 0, v9
    s_nop 1
    v_cndmask_b32 v4, 0, v8, vcc
    v_cmp_eq_u32 vcc, 1, v9
    s_nop 1
    v_cndmask_b32 v5, 0, v8, vcc
    v_cmp_eq_u32 vcc, 2, v9
    s_nop 1
    v_cndmask_b32 v6, 0, v8, vcc
    v_cmp_eq_u32 vcc, 3, v9
    s_nop 1
    v_cndmask_b32 v7, 0, v8, vcc
    s_mov_b32 s58, 0xcccccccc
    s_mov_b32 s59, 0xcccccccc
    s_mov_b32 s60, 0xaaaaaaaa
    s_mov_b32 s61, 0xaaaaaaaa
    s_mov_b32 s50, 0
    s_barrier
    ds_read_b128 v[8:11], v1 offset:23040
    ds_read_b128 v[12:15], v1 offset:23296
    s_waitcnt lgkmcnt(0)
L_kloop:
    v_dot2_f32_bf16 v16, v40, v8, 0
    v_dot2_f32_bf16 v16, v41, v9, v16
    v_dot2_f32_bf16 v16, v42, v10, v16
    v_dot2_f32_bf16 v16, v43, v11, v16
    v_dot2_f32_bf16 v16, v44, v12, v16
    v_dot2_f32_bf16 v16, v45, v13, v16
    v_dot2_f32_bf16 v16, v46, v14, v16
    v_dot2_f32_bf16 v16, v47, v15, v16
    s_waitcnt vmcnt(6)
    buffer_load_dwordx4 v[40:43], v36, s[32:35], s64 offen nt
    s_waitcnt vmcnt(6)
    buffer_load_dwordx4 v[44:47], v36, s[32:35], s64 offen offset:256 nt
    v_dot2_f32_bf16 v17, v48, v8, 0
    v_dot2_f32_bf16 v17, v49, v9, v17
    v_dot2_f32_bf16 v17, v50, v10, v17
    v_dot2_f32_bf16 v17, v51, v11, v17
    v_dot2_f32_bf16 v17, v52, v12, v17
    v_dot2_f32_bf16 v17, v53, v13, v17
    v_dot2_f32_bf16 v17, v54, v14, v17
    v_dot2_f32_bf16 v17, v55, v15, v17
    s_waitcnt vmcnt(6)
    buffer_load_dwordx4 v[48:51], v36, s[32:35], s64 offen offset:2048 nt
    s_waitcnt vmcnt(6)
    buffer_load_dwordx4 v[52:55], v36, s[32:35], s64 offen offset:2304 nt
    v_dot2_f32_bf16 v18, v56, v8, 0
    v_dot2_f32_bf16 v18, v57, v9, v18
    v_dot2_f32_bf16 v18, v58, v10, v18
    v_dot2_f32_bf16 v18, v59, v11, v18
    v_dot2_f32_bf16 v18, v60, v12, v18
    v_dot2_f32_bf16 v18, v61, v13, v18
    v_dot2_f32_bf16 v18, v62, v14, v18
    v_dot2_f32_bf16 v18, v63, v15, v18
    s_waitcnt vmcnt(6)
    buffer_load_dwordx4 v[56:59], v37, s[32:35], s64 offen nt
    s_waitcnt vmcnt(6)
    buffer_load_dwordx4 v[60:63], v37, s[32:35], s64 offen offset:256 nt
    v_dot2_f32_bf16 v19, v64, v8, 0
    v_dot2_f32_bf16 v19, v65, v9, v19
    v_dot2_f32_bf16 v19, v66, v10, v19
    v_dot2_f32_bf16 v19, v67, v11, v19
    v_dot2_f32_bf16 v19, v68, v12, v19
    v_dot2_f32_bf16 v19, v69, v13, v19
    v_dot2_f32_bf16 v19, v70, v14, v19
    v_dot2_f32_bf16 v19, v71, v15, v19
    s_waitcnt vmcnt(6)
    buffer_load_dwordx4 v[64:67], v37, s[32:35], s64 offen offset:2048 nt
    s_waitcnt vmcnt(6)
    buffer_load_dwordx4 v[68:71], v37, s[32:35], s64 offen offset:2304 nt
    v_dot2_f32_bf16 v20, v72, v8, 0
    v_dot2_f32_bf16 v20, v73, v9, v20
    v_dot2_f32_bf16 v20, v74, v10, v20
    v_dot2_f32_bf16 v20, v75, v11, v20
    v_dot2_f32_bf16 v20, v76, v12, v20
    v_dot2_f32_bf16 v20, v77, v13, v20
    v_dot2_f32_bf16 v20, v78, v14, v20
    v_dot2_f32_bf16 v20, v79, v15, v20
    s_waitcnt vmcnt(6)
    buffer_load_dwordx4 v[72:75], v36, s[32:35], s65 offen nt
    s_waitcnt vmcnt(6)
    buffer_load_dwordx4 v[76:79], v36, s[32:35], s65 offen offset:256 nt
    v_dot2_f32_bf16 v21, v80, v8, 0
    v_dot2_f32_bf16 v21, v81, v9, v21
    v_dot2_f32_bf16 v21, v82, v10, v21
    v_dot2_f32_bf16 v21, v83, v11, v21
    v_dot2_f32_bf16 v21, v84, v12, v21
    v_dot2_f32_bf16 v21, v85, v13, v21
    v_dot2_f32_bf16 v21, v86, v14, v21
    v_dot2_f32_bf16 v21, v87, v15, v21
    s_waitcnt vmcnt(6)
    buffer_load_dwordx4 v[80:83], v36, s[32:35], s65 offen offset:2048 nt
    s_waitcnt vmcnt(6)
    buffer_load_dwordx4 v[84:87], v36, s[32:35], s65 offen offset:2304 nt
    v_dot2_f32_bf16 v22, v88, v8, 0
    v_dot2_f32_bf16 v22, v89, v9, v22
    v_dot2_f32_bf16 v22, v90, v10, v22
    v_dot2_f32_bf16 v22, v91, v11, v22
    v_dot2_f32_bf16 v22, v92, v12, v22
    v_dot2_f32_bf16 v22, v93, v13, v22
    v_dot2_f32_bf16 v22, v94, v14, v22
    v_dot2_f32_bf16 v22, v95, v15, v22
    s_waitcnt vmcnt(6)
    buffer_load_dwordx4 v[88:91], v37, s[32:35], s65 offen nt
    s_waitcnt vmcnt(6)
    buffer_load_dwordx4 v[92:95], v37, s[32:35], s65 offen offset:256 nt
    v_dot2_f32_bf16 v23, v96, v8, 0
    v_dot2_f32_bf16 v23, v97, v9, v23
    v_dot2_f32_bf16 v23, v98, v10, v23
    v_dot2_f32_bf16 v23, v99, v11, v23
    v_dot2_f32_bf16 v23, v100, v12, v23
    v_dot2_f32_bf16 v23, v101, v13, v23
    v_dot2_f32_bf16 v23, v102, v14, v23
    v_dot2_f32_bf16 v23, v103, v15, v23
    s_waitcnt vmcnt(6)
    buffer_load_dwordx4 v[96:99], v37, s[32:35], s65 offen offset:2048 nt
    s_waitcnt vmcnt(6)
    buffer_load_dwordx4 v[100:103], v37, s[32:35], s65 offen offset:2304 nt
    v_dot2_f32_bf16 v24, v104, v8, 0
    v_dot2_f32_bf16 v24, v105, v9, v24
    v_dot2_f32_bf16 v24, v106, v10, v24
    v_dot2_f32_bf16 v24, v107, v11, v24
    v_dot2_f32_bf16 v24, v108, v12, v24
    v_dot2_f32_bf16 v24, v109, v13, v24
    v_dot2_f32_bf16 v24, v110, v14, v24
    v_dot2_f32_bf16 v24, v111, v15, v24
    s_waitcnt vmcnt(6)
    buffer_load_dwordx4 v[104:107], v36, s[32:35], s66 offen nt
    s_waitcnt vmcnt(6)
    buffer_load_dwordx4 v[108:111], v36, s[32:35], s66 offen offset:256 nt
    v_dot2_f32_bf16 v25, v112, v8, 0
    v_dot2_f32_bf16 v25, v113, v9, v25
    v_dot2_f32_bf16 v25, v114, v10, v25
    v_dot2_f32_bf16 v25, v115, v11, v25
    v_dot2_f32_bf16 v25, v116, v12, v25
    v_dot2_f32_bf16 v25, v117, v13, v25
    v_dot2_f32_bf16 v25, v118, v14, v25
    v_dot2_f32_bf16 v25, v119, v15, v25
    s_waitcnt vmcnt(6)
    buffer_load_dwordx4 v[112:115], v36, s[32:35], s66 offen offset:2048 nt
    s_waitcnt vmcnt(6)
    buffer_load_dwordx4 v[116:119], v36, s[32:35], s66 offen offset:2304 nt
    v_dot2_f32_bf16 v26, v120, v8, 0
    v_dot2_f32_bf16 v26, v121, v9, v26
    v_dot2_f32_bf16 v26, v122, v10, v26
    v_dot2_f32_bf16 v26, v123, v11, v26
    v_dot2_f32_bf16 v26, v124, v12, v26
    v_dot2_f32_bf16 v26, v125, v13, v26
    v_dot2_f32_bf16 v26, v126, v14, v26
    v_dot2_f32_bf16 v26, v127, v15, v26
    s_waitcnt vmcnt(6)
    buffer_load_dwordx4 v[120:123], v37, s[32:35], s66 offen nt
    s_waitcnt vmcnt(6)
    buffer_load_dwordx4 v[124:127], v37, s[32:35], s66 offen offset:256 nt
    v_dot2_f32_bf16 v27, v128, v8, 0
    v_dot2_f32_bf16 v27, v129, v9, v27
    v_dot2_f32_bf16 v27, v130, v10, v27
    v_dot2_f32_bf16 v27, v131, v11, v27
    v_dot2_f32_bf16 v27, v132, v12, v27
    v_dot2_f32_bf16 v27, v133, v13, v27
    v_dot2_f32_bf16 v27, v134, v14, v27
    v_dot2_f32_bf16 v27, v135, v15, v27
    s_waitcnt vmcnt(6)
    buffer_load_dwordx4 v[128:131], v37, s[32:35], s66 offen offset:2048 nt
    s_waitcnt vmcnt(6)
    buffer_load_dwordx4 v[132:135], v37, s[32:35], s66 offen offset:2304 nt
    v_dot2_f32_bf16 v28, v136, v8, 0
    v_dot2_f32_bf16 v28, v137, v9, v28
    v_dot2_f32_bf16 v28, v138, v10, v28
    v_dot2_f32_bf16 v28, v139, v11, v28
    v_dot2_f32_bf16 v28, v140, v12, v28
    v_dot2_f32_bf16 v28, v141, v13, v28
    v_dot2_f32_bf16 v28, v142, v14, v28
    v_dot2_f32_bf16 v28, v143, v15, v28
    s_waitcnt vmcnt(6)
    buffer_load_dwordx4 v[136:139], v36, s[32:35], s67 offen nt
    s_waitcnt vmcnt(6)
    buffer_load_dwordx4 v[140:143], v36, s[32:35], s67 offen offset:256 nt
    v_dot2_f32_bf16 v29, v144, v8, 0
    v_dot2_f32_bf16 v29, v145, v9, v29
    v_dot2_f32_bf16 v29, v146, v10, v29
    v_dot2_f32_bf16 v29, v147, v11, v29
    v_dot2_f32_bf16 v29, v148, v12, v29
    v_dot2_f32_bf16 v29, v149, v13, v29
    v_dot2_f32_bf16 v29, v150, v14, v29
    v_dot2_f32_bf16 v29, v151, v15, v29
    s_waitcnt vmcnt(6)
    buffer_load_dwordx4 v[144:147], v36, s[32:35], s67 offen offset:2048 nt
    s_waitcnt vmcnt(6)
    buffer_load_dwordx4 v[148:151], v36, s[32:35], s67 offen offset:2304 nt
    v_dot2_f32_bf16 v30, v152, v8, 0
    v_dot2_f32_bf16 v30, v153, v9, v30
    v_dot2_f32_bf16 v30, v154, v10, v30
    v_dot2_f32_bf16 v30, v155, v11, v30
    v_dot2_f32_bf16 v30, v156, v12, v30
    v_dot2_f32_bf16 v30, v157, v13, v30
    v_dot2_f32_bf16 v30, v158, v14, v30
    v_dot2_f32_bf16 v30, v159, v15, v30
    s_waitcnt vmcnt(6)
    buffer_load_dwordx4 v[152:155], v37, s[32:35], s67 offen nt
    s_waitcnt vmcnt(6)
    buffer_load_dwordx4 v[156:159], v37, s[32:35], s67 offen offset:256 nt
    v_dot2_f32_bf16 v31, v160, v8, 0
    v_dot2_f32_bf16 v31, v161, v9, v31
    v_dot2_f32_bf16 v31, v162, v10, v31
    v_dot2_f32_bf16 v31, v163, v11, v31
    v_dot2_f32_bf16 v31, v164, v12, v31
    v_dot2_f32_bf16 v31, v165, v13, v31
    v_dot2_f32_bf16 v31, v166, v14, v31
    v_dot2_f32_bf16 v31, v167, v15, v31
    s_waitcnt vmcnt(6)
    buffer_load_dwordx4 v[160:163], v37, s[32:35], s67 offen offset:2048 nt
    s_waitcnt vmcnt(6)
    buffer_load_dwordx4 v[164:167], v37, s[32:35], s67 offen offset:2304 nt
    s_add_u32 s32, s32, 131072
    s_addc_u32 s33, s33, 0
    s_cmp_eq_u32 s50, 2
    s_cselect_b32 s32, s56, s32
    s_cselect_b32 s33, s57, s33
    v_add_f32_dpp v16, v16, v16 row_ror:8 row_mask:0xf bank_mask:0x3
    v_add_f32_dpp v17, v17, v17 row_ror:8 row_mask:0xf bank_mask:0x3
    v_add_f32_dpp v18, v18, v18 row_ror:8 row_mask:0xf bank_mask:0x3
    v_add_f32_dpp v19, v19, v19 row_ror:8 row_mask:0xf bank_mask:0x3
    v_add_f32_dpp v20, v20, v20 row_ror:8 row_mask:0xf bank_mask:0x3
    v_add_f32_dpp v21, v21, v21 row_ror:8 row_mask:0xf bank_mask:0x3
    v_add_f32_dpp v22, v22, v22 row_ror:8 row_mask:0xf bank_mask:0x3
    v_add_f32_dpp v23, v23, v23 row_ror:8 row_mask:0xf bank_mask:0x3
    v_add_f32_dpp v16, v24, v24 row_ror:8 row_mask:0xf bank_mask:0xc
    v_add_f32_dpp v17, v25, v25 row_ror:8 row_mask:0xf bank_mask:0xc
    v_add_f32_dpp v18, v26, v26 row_ror:8 row_mask:0xf bank_mask:0xc
    v_add_f32_dpp v19, v27, v27 row_ror:8 row_mask:0xf bank_mask:0xc
    v_add_f32_dpp v20, v28, v28 row_ror:8 row_mask:0xf bank_mask:0xc
    v_add_f32_dpp v21, v29, v29 row_ror:8 row_mask:0xf bank_mask:0xc
    v_add_f32_dpp v22, v30, v30 row_ror:8 row_mask:0xf bank_mask:0xc
    v_add_f32_dpp v23, v31, v31 row_ror:8 row_mask:0xf bank_mask:0xc
    v_add_f32_dpp v16, v16, v16 row_shl:4 row_mask:0xf bank_mask:0x5
    v_add_f32_dpp v17, v17, v17 row_shl:4 row_mask:0xf bank_mask:0x5
    v_add_f32_dpp v18, v18, v18 row_shl:4 row_mask:0xf bank_mask:0x5
    v_add_f32_dpp v19, v19, v19 row_shl:4 row_mask:0xf bank_mask:0x5
    v_add_f32_dpp v16, v20, v20 row_shr:4 row_mask:0xf bank_mask:0xa
    v_add_f32_dpp v17, v21, v21 row_shr:4 row_mask:0xf bank_mask:0xa
    v_add_f32_dpp v18, v22, v22 row_shr:4 row_mask:0xf bank_mask:0xa
    v_add_f32_dpp v19, v23, v23 row_shr:4 row_mask:0xf bank_mask:0xa
    v_add_f32_dpp v16, v16, v16 quad_perm:[2,3,0,1] row_mask:0xf bank_mask:0xf
    v_add_f32_dpp v17, v17, v17 quad_perm:[2,3,0,1] row_mask:0xf bank_mask:0xf
    v_add_f32_dpp v18, v18, v18 quad_perm:[2,3,0,1] row_mask:0xf bank_mask:0xf
    v_add_f32_dpp v19, v19, v19 quad_perm:[2,3,0,1] row_mask:0xf bank_mask:0xf
    v_cndmask_b32 v16, v16, v18, s[58:59]
    v_cndmask_b32 v17, v17, v19, s[58:59]
    v_mov_b32 v32, v33
    v_mov_b32 v33, v34
    v_mov_b32 v34, v35
    v_add_f32_dpp v16, v16, v16 quad_perm:[1,0,3,2] row_mask:0xf bank_mask:0xf
    v_add_f32_dpp v17, v17, v17 quad_perm:[1,0,3,2] row_mask:0xf bank_mask:0xf
    v_cndmask_b32 v35, v16, v17, s[60:61]
    v_cvt_pk_bf16_f32 v35, v35, v35
    v_and_b32 v35, 0xffff0000, v35
    v_mul_f32 v35, 0x3db8aa3b, v35
    s_add_u32 s50, s50, 1
    s_cmp_lt_u32 s50, 4
    s_cbranch_scc1 L_kloop
    v_max_f32 v38, v32, v33
    v_max3_f32 v38, v38, v34, v35
    s_nop 1
    v_max_f32_dpp v38, v38, v38 row_ror:8 row_mask:0xf bank_mask:0xf
    s_nop 1
    v_max_f32_dpp v38, v38, v38 row_ror:4 row_mask:0xf bank_mask:0xf
    s_nop 1
    v_max_f32_dpp v38, v38, v38 row_ror:2 row_mask:0xf bank_mask:0xf
    s_nop 1
    v_max_f32_dpp v38, v38, v38 row_ror:1 row_mask:0xf bank_mask:0xf
    s_nop 0
    v_readlane_b32 s68, v38, 0
    v_readlane_b32 s69, v38, 16
    v_readlane_b32 s70, v38, 32
    v_readlane_b32 s71, v38, 48
    s_nop 1
    v_mov_b32 v38, s68
    v_max_f32 v38, s69, v38
    v_max_f32 v38, s70, v38
    v_max_f32 v38, s71, v38
    v_sub_f32 v32, v32, v38
    v_sub_f32 v33, v33, v38
    v_sub_f32 v34, v34, v38
    v_sub_f32 v35, v35, v38
    v_exp_f32 v32, v32
    v_exp_f32 v33, v33
    v_exp_f32 v34, v34
    v_exp_f32 v35, v35
    v_mov_b32 v8, 0
    v_mov_b32 v9, 0
    v_mov_b32 v10, 0
    v_mov_b32 v11, 0
    v_mov_b32 v12, 0
    v_mov_b32 v13, 0
    v_mov_b32 v14, 0
    v_mov_b32 v15, 0
    v_add_f32 v39, v32, v33
    v_add_f32 v39, v39, v34
    v_add_f32 v39, v39, v35
    v_cvt_pk_bf16_f32 v32, v32, v32
    v_cvt_pk_bf16_f32 v33, v33, v33
    v_cvt_pk_bf16_f32 v34, v34, v34
    v_cvt_pk_bf16_f32 v35, v35, v35
    s_mov_b32 s50, 0
    s_mov_b64 vcc, 0
L_vloop:
    v_and_b32_dpp v16, v32, v4 row_newbcast:0 row_mask:0xf bank_mask:0xf
    v_and_b32_dpp v17, v32, v5 row_newbcast:0 row_mask:0xf bank_mask:0xf
    v_and_b32_dpp v18, v32, v6 row_newbcast:0 row_mask:0xf bank_mask:0xf
    v_and_b32_dpp v19, v32, v7 row_newbcast:0 row_mask:0xf bank_mask:0xf
    s_nop 1
    v_mfma_f32_16x16x32_bf16 v[8:11], v[16:19], v[40:43], v[8:11]
    v_mfma_f32_16x16x32_bf16 v[12:15], v[16:19], v[44:47], v[12:15]
    s_cbranch_vccnz S_1
    s_waitcnt vmcnt(6)
    buffer_load_dwordx4 v[40:43], v36, s[32:35], s64 offen nt
    s_waitcnt vmcnt(6)
    buffer_load_dwordx4 v[44:47], v36, s[32:35], s64 offen offset:256 nt
S_1:
    v_and_b32_dpp v20, v32, v4 row_newbcast:1 row_mask:0xf bank_mask:0xf
    v_and_b32_dpp v21, v32, v5 row_newbcast:1 row_mask:0xf bank_mask:0xf
    v_and_b32_dpp v22, v32, v6 row_newbcast:1 row_mask:0xf bank_mask:0xf
    v_and_b32_dpp v23, v32, v7 row_newbcast:1 row_mask:0xf bank_mask:0xf
    s_nop 1
    v_mfma_f32_16x16x32_bf16 v[8:11], v[20:23], v[48:51], v[8:11]
    v_mfma_f32_16x16x32_bf16 v[12:15], v[20:23], v[52:55], v[12:15]
    s_cbranch_vccnz S_2
    s_waitcnt vmcnt(6)
    buffer_load_dwordx4 v[48:51], v36, s[32:35], s64 offen offset:2048 nt
    s_waitcnt vmcnt(6)
    buffer_load_dwordx4 v[52:55], v36, s[32:35], s64 offen offset:2304 nt
S_2:
    v_and_b32_dpp v16, v32, v4 row_newbcast:2 row_mask:0xf bank_mask:0xf
    v_and_b32_dpp v17, v32, v5 row_newbcast:2 row_mask:0xf bank_mask:0xf
    v_and_b32_dpp v18, v32, v6 row_newbcast:2 row_mask:0xf bank_mask:0xf
    v_and_b32_dpp v19, v32, v7 row_newbcast:2 row_mask:0xf bank_mask:0xf
    s_nop 1
    v_mfma_f32_16x16x32_bf16 v[8:11], v[16:19], v[56:59], v[8:11]
    v_mfma_f32_16x16x32_bf16 v[12:15], v[16:19], v[60:63], v[12:15]
    s_cbranch_vccnz S_3
    s_waitcnt vmcnt(6)
    buffer_load_dwordx4 v[56:59], v37, s[32:35], s64 offen nt
    s_waitcnt vmcnt(6)
    buffer_load_dwordx4 v[60:63], v37, s[32:35], s64 offen offset:256 nt
S_3:
    v_and_b32_dpp v20, v32, v4 row_newbcast:3 row_mask:0xf bank_mask:0xf
    v_and_b32_dpp v21, v32, v5 row_newbcast:3 row_mask:0xf bank_mask:0xf
    v_and_b32_dpp v22, v32, v6 row_newbcast:3 row_mask:0xf bank_mask:0xf
    v_and_b32_dpp v23, v32, v7 row_newbcast:3 row_mask:0xf bank_mask:0xf
    s_nop 1
    v_mfma_f32_16x16x32_bf16 v[8:11], v[20:23], v[64:67], v[8:11]
    v_mfma_f32_16x16x32_bf16 v[12:15], v[20:23], v[68:71], v[12:15]
    s_cbranch_vccnz S_4
    s_waitcnt vmcnt(6)
    buffer_load_dwordx4 v[64:67], v37, s[32:35], s64 offen offset:2048 nt
    s_waitcnt vmcnt(6)
    buffer_load_dwordx4 v[68:71], v37, s[32:35], s64 offen offset:2304 nt
S_4:
    v_and_b32_dpp v16, v32, v4 row_newbcast:4 row_mask:0xf bank_mask:0xf
    v_and_b32_dpp v17, v32, v5 row_newbcast:4 row_mask:0xf bank_mask:0xf
    v_and_b32_dpp v18, v32, v6 row_newbcast:4 row_mask:0xf bank_mask:0xf
    v_and_b32_dpp v19, v32, v7 row_newbcast:4 row_mask:0xf bank_mask:0xf
    s_nop 1
    v_mfma_f32_16x16x32_bf16 v[8:11], v[16:19], v[72:75], v[8:11]
    v_mfma_f32_16x16x32_bf16 v[12:15], v[16:19], v[76:79], v[12:15]
    s_cbranch_vccnz S_5
    s_waitcnt vmcnt(6)
    buffer_load_dwordx4 v[72:75], v36, s[32:35], s65 offen nt
    s_waitcnt vmcnt(6)
    buffer_load_dwordx4 v[76:79], v36, s[32:35], s65 offen offset:256 nt
S_5:
    v_and_b32_dpp v20, v32, v4 row_newbcast:5 row_mask:0xf bank_mask:0xf
    v_and_b32_dpp v21, v32, v5 row_newbcast:5 row_mask:0xf bank_mask:0xf
    v_and_b32_dpp v22, v32, v6 row_newbcast:5 row_mask:0xf bank_mask:0xf
    v_and_b32_dpp v23, v32, v7 row_newbcast:5 row_mask:0xf bank_mask:0xf
    s_nop 1
    v_mfma_f32_16x16x32_bf16 v[8:11], v[20:23], v[80:83], v[8:11]
    v_mfma_f32_16x16x32_bf16 v[12:15], v[20:23], v[84:87], v[12:15]
    s_cbranch_vccnz S_6
    s_waitcnt vmcnt(6)
    buffer_load_dwordx4 v[80:83], v36, s[32:35], s65 offen offset:2048 nt
    s_waitcnt vmcnt(6)
    buffer_load_dwordx4 v[84:87], v36, s[32:35], s65 offen offset:2304 nt
S_6:
    v_and_b32_dpp v16, v32, v4 row_newbcast:6 row_mask:0xf bank_mask:0xf
    v_and_b32_dpp v17, v32, v5 row_newbcast:6 row_mask:0xf bank_mask:0xf
    v_and_b32_dpp v18, v32, v6 row_newbcast:6 row_mask:0xf bank_mask:0xf
    v_and_b32_dpp v19, v32, v7 row_newbcast:6 row_mask:0xf bank_mask:0xf
    s_nop 1
    v_mfma_f32_16x16x32_bf16 v[8:11], v[16:19], v[88:91], v[8:11]
    v_mfma_f32_16x16x32_bf16 v[12:15], v[16:19], v[92:95], v[12:15]
    s_cbranch_vccnz S_7
    s_waitcnt vmcnt(6)
    buffer_load_dwordx4 v[88:91], v37, s[32:35], s65 offen nt
    s_waitcnt vmcnt(6)
    buffer_load_dwordx4 v[92:95], v37, s[32:35], s65 offen offset:256 nt
S_7:
    v_and_b32_dpp v20, v32, v4 row_newbcast:7 row_mask:0xf bank_mask:0xf
    v_and_b32_dpp v21, v32, v5 row_newbcast:7 row_mask:0xf bank_mask:0xf
    v_and_b32_dpp v22, v32, v6 row_newbcast:7 row_mask:0xf bank_mask:0xf
    v_and_b32_dpp v23, v32, v7 row_newbcast:7 row_mask:0xf bank_mask:0xf
    s_nop 1
    v_mfma_f32_16x16x32_bf16 v[8:11], v[20:23], v[96:99], v[8:11]
    v_mfma_f32_16x16x32_bf16 v[12:15], v[20:23], v[100:103], v[12:15]
    s_cbranch_vccnz S_8
    s_waitcnt vmcnt(6)
    buffer_load_dwordx4 v[96:99], v37, s[32:35], s65 offen offset:2048 nt
    s_waitcnt vmcnt(6)
    buffer_load_dwordx4 v[100:103], v37, s[32:35], s65 offen offset:2304 nt
S_8:
    s_cbranch_vccz W_9
    s_waitcnt vmcnt(8)
W_9:
    v_and_b32_dpp v16, v32, v4 row_newbcast:8 row_mask:0xf bank_mask:0xf
    v_and_b32_dpp v17, v32, v5 row_newbcast:8 row_mask:0xf bank_mask:0xf
    v_and_b32_dpp v18, v32, v6 row_newbcast:8 row_mask:0xf bank_mask:0xf
    v_and_b32_dpp v19, v32, v7 row_newbcast:8 row_mask:0xf bank_mask:0xf
    s_nop 1
    v_mfma_f32_16x16x32_bf16 v[8:11], v[16:19], v[104:107], v[8:11]
    v_mfma_f32_16x16x32_bf16 v[12:15], v[16:19], v[108:111], v[12:15]
    s_cbranch_vccnz S_10
    s_waitcnt vmcnt(6)
    buffer_load_dwordx4 v[104:107], v36, s[32:35], s66 offen nt
    s_waitcnt vmcnt(6)
    buffer_load_dwordx4 v[108:111], v36, s[32:35], s66 offen offset:256 nt
S_10:
    v_and_b32_dpp v20, v32, v4 row_newbcast:9 row_mask:0xf bank_mask:0xf
    v_and_b32_dpp v21, v32, v5 row_newbcast:9 row_mask:0xf bank_mask:0xf
    v_and_b32_dpp v22, v32, v6 row_newbcast:9 row_mask:0xf bank_mask:0xf
    v_and_b32_dpp v23, v32, v7 row_newbcast:9 row_mask:0xf bank_mask:0xf
    s_nop 1
    v_mfma_f32_16x16x32_bf16 v[8:11], v[20:23], v[112:115], v[8:11]
    v_mfma_f32_16x16x32_bf16 v[12:15], v[20:23], v[116:119], v[12:15]
    s_cbranch_vccnz S_11
    s_waitcnt vmcnt(6)
    buffer_load_dwordx4 v[112:115], v36, s[32:35], s66 offen offset:2048 nt
    s_waitcnt vmcnt(6)
    buffer_load_dwordx4 v[116:119], v36, s[32:35], s66 offen offset:2304 nt
S_11:
    v_and_b32_dpp v16, v32, v4 row_newbcast:10 row_mask:0xf bank_mask:0xf
    v_and_b32_dpp v17, v32, v5 row_newbcast:10 row_mask:0xf bank_mask:0xf
    v_and_b32_dpp v18, v32, v6 row_newbcast:10 row_mask:0xf bank_mask:0xf
    v_and_b32_dpp v19, v32, v7 row_newbcast:10 row_mask:0xf bank_mask:0xf
    s_nop 1
    v_mfma_f32_16x16x32_bf16 v[8:11], v[16:19], v[120:123], v[8:11]
    v_mfma_f32_16x16x32_bf16 v[12:15], v[16:19], v[124:127], v[12:15]
    s_cbranch_vccnz S_12
    s_waitcnt vmcnt(6)
    buffer_load_dwordx4 v[120:123], v37, s[32:35], s66 offen nt
    s_waitcnt vmcnt(6)
    buffer_load_dwordx4 v[124:127], v37, s[32:35], s66 offen offset:256 nt
S_12:
    v_and_b32_dpp v20, v32, v4 row_newbcast:11 row_mask:0xf bank_mask:0xf
    v_and_b32_dpp v21, v32, v5 row_newbcast:11 row_mask:0xf bank_mask:0xf
    v_and_b32_dpp v22, v32, v6 row_newbcast:11 row_mask:0xf bank_mask:0xf
    v_and_b32_dpp v23, v32, v7 row_newbcast:11 row_mask:0xf bank_mask:0xf
    s_nop 1
    v_mfma_f32_16x16x32_bf16 v[8:11], v[20:23], v[128:131], v[8:11]
    v_mfma_f32_16x16x32_bf16 v[12:15], v[20:23], v[132:135], v[12:15]
    s_cbranch_vccnz S_13
    s_waitcnt vmcnt(6)
    buffer_load_dwordx4 v[128:131], v37, s[32:35], s66 offen offset:2048 nt
    s_waitcnt vmcnt(6)
    buffer_load_dwordx4 v[132:135], v37, s[32:35], s66 offen offset:2304 nt
S_13:
    s_cbranch_vccz W_14
    s_waitcnt vmcnt(0)
W_14:
    v_and_b32_dpp v16, v32, v4 row_newbcast:12 row_mask:0xf bank_mask:0xf
    v_and_b32_dpp v17, v32, v5 row_newbcast:12 row_mask:0xf bank_mask:0xf
    v_and_b32_dpp v18, v32, v6 row_newbcast:12 row_mask:0xf bank_mask:0xf
    v_and_b32_dpp v19, v32, v7 row_newbcast:12 row_mask:0xf bank_mask:0xf
    s_nop 1
    v_mfma_f32_16x16x32_bf16 v[8:11], v[16:19], v[136:139], v[8:11]
    v_mfma_f32_16x16x32_bf16 v[12:15], v[16:19], v[140:143], v[12:15]
    s_cbranch_vccnz S_15
    s_waitcnt vmcnt(6)
    buffer_load_dwordx4 v[136:139], v36, s[32:35], s67 offen nt
    s_waitcnt vmcnt(6)
    buffer_load_dwordx4 v[140:143], v36, s[32:35], s67 offen offset:256 nt
S_15:
    v_and_b32_dpp v20, v32, v4 row_newbcast:13 row_mask:0xf bank_mask:0xf
    v_and_b32_dpp v21, v32, v5 row_newbcast:13 row_mask:0xf bank_mask:0xf
    v_and_b32_dpp v22, v32, v6 row_newbcast:13 row_mask:0xf bank_mask:0xf
    v_and_b32_dpp v23, v32, v7 row_newbcast:13 row_mask:0xf bank_mask:0xf
    s_nop 1
    v_mfma_f32_16x16x32_bf16 v[8:11], v[20:23], v[144:147], v[8:11]
    v_mfma_f32_16x16x32_bf16 v[12:15], v[20:23], v[148:151], v[12:15]
    s_cbranch_vccnz S_16
    s_waitcnt vmcnt(6)
    buffer_load_dwordx4 v[144:147], v36, s[32:35], s67 offen offset:2048 nt
    s_waitcnt vmcnt(6)
    buffer_load_dwordx4 v[148:151], v36, s[32:35], s67 offen offset:2304 nt
S_16:
    v_and_b32_dpp v16, v32, v4 row_newbcast:14 row_mask:0xf bank_mask:0xf
    v_and_b32_dpp v17, v32, v5 row_newbcast:14 row_mask:0xf bank_mask:0xf
    v_and_b32_dpp v18, v32, v6 row_newbcast:14 row_mask:0xf bank_mask:0xf
    v_and_b32_dpp v19, v32, v7 row_newbcast:14 row_mask:0xf bank_mask:0xf
    s_nop 1
    v_mfma_f32_16x16x32_bf16 v[8:11], v[16:19], v[152:155], v[8:11]
    v_mfma_f32_16x16x32_bf16 v[12:15], v[16:19], v[156:159], v[12:15]
    s_cbranch_vccnz S_17
    s_waitcnt vmcnt(6)
    buffer_load_dwordx4 v[152:155], v37, s[32:35], s67 offen nt
    s_waitcnt vmcnt(6)
    buffer_load_dwordx4 v[156:159], v37, s[32:35], s67 offen offset:256 nt
S_17:
    v_and_b32_dpp v20, v32, v4 row_newbcast:15 row_mask:0xf bank_mask:0xf
    v_and_b32_dpp v21, v32, v5 row_newbcast:15 row_mask:0xf bank_mask:0xf
    v_and_b32_dpp v22, v32, v6 row_newbcast:15 row_mask:0xf bank_mask:0xf
    v_and_b32_dpp v23, v32, v7 row_newbcast:15 row_mask:0xf bank_mask:0xf
    s_nop 1
    v_mfma_f32_16x16x32_bf16 v[8:11], v[20:23], v[160:163], v[8:11]
    v_mfma_f32_16x16x32_bf16 v[12:15], v[20:23], v[164:167], v[12:15]
    s_cbranch_vccnz S_18
    s_waitcnt vmcnt(6)
    buffer_load_dwordx4 v[160:163], v37, s[32:35], s67 offen offset:2048 nt
    s_waitcnt vmcnt(6)
    buffer_load_dwordx4 v[164:167], v37, s[32:35], s67 offen offset:2304 nt
S_18:
    s_cbranch_vccnz L_vdone
    s_add_u32 s32, s32, 131072
    s_addc_u32 s33, s33, 0
    v_mov_b32 v32, v33
    v_mov_b32 v33, v34
    v_mov_b32 v34, v35
    s_add_u32 s50, s50, 1
    s_cmp_eq_u32 s50, 2
    s_cbranch_scc1 L_vloop
    s_cmp_eq_u32 s50, 3
    s_cbranch_scc1 L_vlast
    s_nop 1
    v_add_f32_dpp v39, v39, v39 row_ror:8 row_mask:0xf bank_mask:0xf
    s_nop 1
    v_add_f32_dpp v39, v39, v39 row_ror:4 row_mask:0xf bank_mask:0xf
    s_nop 1
    v_add_f32_dpp v39, v39, v39 row_ror:2 row_mask:0xf bank_mask:0xf
    s_nop 1
    v_add_f32_dpp v39, v39, v39 row_ror:1 row_mask:0xf bank_mask:0xf
    s_nop 0
    v_readlane_b32 s68, v39, 0
    v_readlane_b32 s69, v39, 16
    v_readlane_b32 s70, v39, 32
    v_readlane_b32 s71, v39, 48
    s_nop 1
    v_mov_b32 v39, s68
    v_add_f32 v39, s69, v39
    v_add_f32 v39, s70, v39
    v_add_f32 v39, s71, v39
    s_lshl_b32 s3, s63, 3
    v_mov_b32 v24, s3
    ds_write_b64 v24, v[38:39] offset:25600
    v_mov_b32 v24, 25664
    v_mov_b32 v25, 1
    s_waitcnt lgkmcnt(0)
    s_mov_b64 exec, 1
    ds_add_u32 v24, v25 offset:4
    s_mov_b64 exec, -1
    s_branch L_vloop
L_vlast:
    ds_read_b32 v25, v24 offset:4
    s_waitcnt lgkmcnt(0)
    v_readfirstlane_b32 s3, v25
    s_cmp_lt_u32 s3, 4
    s_cbranch_scc1 L_vlast
    v_mov_b32 v25, 1
    s_mov_b64 exec, 1
    ds_add_u32 v24, v25 offset:12
    s_mov_b64 exec, -1
    v_mov_b32 v25, 25600
    ds_read2_b32 v[26:27], v25 offset0:0 offset1:2
    ds_read2_b32 v[28:29], v25 offset0:4 offset1:6
    v_and_b32 v1, 1, v3
    v_lshlrev_b32 v1, 3, v1
    v_lshl_add_u32 v1, v2, 4, v1
    s_lshl_b32 s3, s63, 9
    v_add_u32 v1, s3, v1
    s_waitcnt lgkmcnt(0)
    v_max_f32 v26, v26, v27
    v_max3_f32 v26, v26, v28, v29
    v_sub_f32 v38, v38, v26
    v_exp_f32 v38, v38
    s_mov_b64 vcc, -1
    s_branch L_vloop
L_vdone:
    s_nop 5
    v_mul_f32 v8, v8, v38
    v_mul_f32 v9, v9, v38
    v_mul_f32 v10, v10, v38
    v_mul_f32 v11, v11, v38
    v_mul_f32 v12, v12, v38
    v_mul_f32 v13, v13, v38
    v_mul_f32 v14, v14, v38
    v_mul_f32 v15, v15, v38
    v_cvt_pk_bf16_f32 v8, v8, v9
    v_cvt_pk_bf16_f32 v9, v10, v11
    v_cvt_pk_bf16_f32 v10, v12, v13
    v_cvt_pk_bf16_f32 v11, v14, v15
    ds_write_b64 v1, v[8:9] offset:23552
    ds_write_b64 v1, v[10:11] offset:23808
    s_waitcnt lgkmcnt(0)
    s_barrier
    s_endpgm
L_helper:
    s_setprio 2
    v_lshrrev_b32 v52, 3, v2
    v_lshl_add_u32 v52, v52, 2, v3
    v_and_b32 v53, 7, v2
    v_lshlrev_b32 v53, 4, v53
    s_mul_i32 s62, s31, 56
    v_and_b32 v14, 63, v0
    v_lshlrev_b32 v14, 4, v14
    v_lshl_add_u32 v15, v2, 2, v3
    v_add_u32 v15, s62, v15
    v_lshlrev_b32 v15, 1, v15
    v_add_u32 v13, s62, v52
    v_lshlrev_b32 v13, 13, v13
    v_add_u32 v13, v13, v53
    s_mov_b32 s48, 0
    s_mov_b32 s49, 65536
    s_mov_b32 s50, 131072
    s_mov_b32 s51, 196608
    s_mov_b32 s52, 262144
    s_mov_b32 s53, 327680
    s_mov_b32 s54, 393216
    s_mul_i32 s3, s28, 896
    s_lshl_b32 s63, s29, 9
    s_lshl_b32 s61, s30, 7
    s_add_u32 s63, s63, s61
    s_lshl_b32 s60, s14, 11
    s_lshl_b32 s58, s59, 11
    s_add_u32 s58, s58, 262144
    s_mov_b32 s64, 8
    s_waitcnt lgkmcnt(0)
    s_add_u32 s36, s4, s3
    s_addc_u32 s37, s5, 0
    s_mov_b32 s38, 896
    s_add_u32 s32, s10, s63
    s_addc_u32 s33, s11, 0
    s_sub_u32 s34, 3670016, s63
    s_add_u32 s40, s26, s60
    s_addc_u32 s41, s27, 0
    s_mov_b32 s42, 2048
    s_add_u32 s44, s26, s58
    s_addc_u32 s45, s27, 0
    s_mov_b32 s46, 2048
    buffer_load_dwordx4 v[8:11], v14, s[36:39], 0 offen
    buffer_load_ushort v12, v15, s[36:39], 0 offen
    buffer_load_dwordx4 v[56:59], v13, s[32:35], s48 offen
    buffer_load_dwordx4 v[60:63], v13, s[32:35], s49 offen
    buffer_load_dwordx4 v[64:67], v13, s[32:35], s50 offen
    buffer_load_dwordx4 v[68:71], v13, s[32:35], s51 offen
    buffer_load_dwordx4 v[72:75], v13, s[32:35], s52 offen
    buffer_load_dwordx4 v[76:79], v13, s[32:35], s53 offen
    buffer_load_dwordx4 v[80:83], v13, s[32:35], s54 offen
    v_mov_b32 v120, -1
    v_mov_b32 v121, -1
    v_mov_b32 v122, -1
    v_mov_b32 v123, -1
    s_and_b32 s3, s31, 5
    s_cmp_lg_u32 s3, 1
    s_cbranch_scc1 L_h_not1
    s_and_b32 s3, s59, 63
    s_lshl_b32 s3, s3, 10
    s_add_u32 s3, s3, 1048576
    s_cmp_eq_u32 s30, s28
    s_cselect_b32 s61, 1024, 0
    s_cmp_eq_u32 s31, 1
    s_cselect_b32 s3, s58, s3
    s_cselect_b32 s46, s46, s61
    s_add_u32 s44, s26, s3
    s_addc_u32 s45, s27, 0
    buffer_store_dwordx4 v[120:123], v14, s[44:47], 0 offen sc0 sc1
    buffer_store_dwordx4 v[120:123], v14, s[44:47], 0 offen offset:1024 sc0 sc1
    s_add_u32 s44, s26, s58
    s_addc_u32 s45, s27, 0
    s_mov_b32 s46, 2048
    s_branch L_h_b0
L_h_not1:
    s_lshl_b32 s3, s30, 7
    v_lshl_add_u32 v48, v2, 3, s3
    s_cmp_eq_u32 s31, 2
    s_cselect_b32 s42, 2048, 0
    s_mov_b64 exec, 0xff
    buffer_store_dwordx2 v[120:121], v48, s[40:43], 0 offen offset:1280 sc0 sc1
    s_mov_b32 s42, 0
    buffer_store_dwordx2 v[120:121], v48, s[40:43], 0 offen offset:1280 sc0 sc1
    s_mov_b64 exec, -1
    s_mov_b32 s42, 2048
L_h_b0:
    s_lshr_b32 s60, s59, 5
    s_mul_i32 s62, s28, 112
    s_and_b32 s71, s59, 31
    s_lshr_b32 s3, s71, 3
    s_sub_u32 s61, s71, s3
    s_and_b32 s3, s31, 3
    s_mul_i32 s3, s3, 896
    s_add_u32 s36, s4, s3
    s_addc_u32 s37, s5, 0
    s_sub_u32 s3, s31, 1
    s_cmp_lt_u32 s3, 4
    s_cselect_b32 s38, 896, 0
    s_bitcmp0_b32 s60, 0
    s_cselect_b32 s32, s16, s18
    s_cselect_b32 s33, s17, s19
    s_and_b32 s3, s31, 1
    s_mul_i32 s3, s3, 56
    s_add_u32 s3, s3, s62
    s_mul_i32 s3, s3, 3584
    s_lshl_b32 s63, s61, 7
    s_add_u32 s3, s3, s63
    s_add_u32 s32, s32, s3
    s_addc_u32 s33, s33, 0
    s_cmp_ge_u32 s31, 6
    s_cselect_b32 s34, 197248, 0
    s_cmp_ge_u32 s15, 56
    s_cselect_b32 s34, 0, s34
    v_lshl_add_u32 v50, v2, 2, v3
    v_add_u32 v50, s62, v50
    v_lshlrev_b32 v50, 1, v50
    s_movk_i32 s3, 3584
    v_mul_lo_u32 v49, v52, s3
    v_add_u32 v49, v49, v53
    s_mov_b32 s48, 0
    s_mov_b32 s49, 28672
    s_mov_b32 s50, 57344
    s_mov_b32 s51, 86016
    s_mov_b32 s52, 114688
    s_mov_b32 s53, 143360
    s_mov_b32 s54, 172032
    buffer_load_dwordx4 v[112:115], v14, s[36:39], 0 offen
    buffer_load_ushort v116, v50, s[36:39], 0 offen
    buffer_load_ushort v117, v50, s[36:39], 0 offen offset:112
    buffer_load_dwordx4 v[84:87], v49, s[32:35], s48 offen
    buffer_load_dwordx4 v[88:91], v49, s[32:35], s49 offen
    buffer_load_dwordx4 v[92:95], v49, s[32:35], s50 offen
    buffer_load_dwordx4 v[96:99], v49, s[32:35], s51 offen
    buffer_load_dwordx4 v[100:103], v49, s[32:35], s52 offen
    buffer_load_dwordx4 v[104:107], v49, s[32:35], s53 offen
    buffer_load_dwordx4 v[108:111], v49, s[32:35], s54 offen
    v_mov_b32 v48, 25664
    v_mov_b32 v20, 0
    v_mov_b32 v21, 0
    v_mov_b32 v22, 0
    v_mov_b32 v23, 0
    ds_write_b128 v48, v[20:23]
    s_waitcnt lgkmcnt(0)
    s_barrier
    s_cmp_lg_u32 s31, 0
    s_cbranch_scc1 L_h_not0
    s_load_dwordx4 s[72:75], s[40:41], 1024 glc
L_h_not0:
    v_and_b32 v50, 1, v2
    v_lshlrev_b32 v50, 4, v50
    v_mov_b32 v51, 0xffff
    v_lshlrev_b32 v50, v50, v51
    v_bfe_u32 v51, v2, 1, 2
    v_cmp_eq_u32 vcc, 0, v51
    s_nop 1
    v_cndmask_b32 v4, 0, v50, vcc
    v_cmp_eq_u32 vcc, 1, v51
    s_nop 1
    v_cndmask_b32 v5, 0, v50, vcc
    v_cmp_eq_u32 vcc, 2, v51
    s_nop 1
    v_cndmask_b32 v6, 0, v50, vcc
    v_cmp_eq_u32 vcc, 3, v51
    s_nop 1
    v_cndmask_b32 v7, 0, v50, vcc
    v_and_b32 v54, 1, v3
    v_lshlrev_b32 v54, 4, v54
    v_lshl_add_u32 v54, v53, 1, v54
    v_lshrrev_b32 v55, 1, v3
    s_lshl_b32 s3, s31, 1
    v_add_u32 v55, s3, v55
    s_mov_b32 s56, 0x00ff00ff
    s_mov_b32 s57, 0xff00ff00
    s_lshl_b32 s3, s14, 2
    s_add_u32 s84, s24, s3
    s_addc_u32 s85, s25, 0
    s_waitcnt vmcnt(19)
    v_lshlrev_b32 v20, 16, v8
    v_and_b32 v21, 0xffff0000, v8
    v_lshlrev_b32 v22, 16, v9
    v_and_b32 v23, 0xffff0000, v9
    v_lshlrev_b32 v24, 16, v10
    v_and_b32 v25, 0xffff0000, v10
    v_lshlrev_b32 v26, 16, v11
    v_and_b32 v27, 0xffff0000, v11
    v_add_f32 v48, v20, v21
    v_add_f32 v48, v48, v22
    v_add_f32 v48, v48, v23
    v_add_f32 v48, v48, v24
    v_add_f32 v48, v48, v25
    v_add_f32 v48, v48, v26
    v_add_f32 v48, v48, v27
    s_nop 1
    v_add_f32_dpp v48, v48, v48 row_ror:8 row_mask:0xf bank_mask:0xf
    s_nop 1
    v_add_f32_dpp v48, v48, v48 row_ror:4 row_mask:0xf bank_mask:0xf
    s_nop 1
    v_add_f32_dpp v48, v48, v48 row_ror:2 row_mask:0xf bank_mask:0xf
    s_nop 1
    v_add_f32_dpp v48, v48, v48 row_ror:1 row_mask:0xf bank_mask:0xf
    s_nop 0
    v_readlane_b32 s68, v48, 0
    v_readlane_b32 s69, v48, 16
    v_readlane_b32 s70, v48, 32
    v_readlane_b32 s71, v48, 48
    s_nop 1
    v_mov_b32 v48, s68
    v_add_f32 v48, s69, v48
    v_add_f32 v48, s70, v48
    v_add_f32 v48, s71, v48
    v_mul_f32 v48, 0x3b124925, v48
    v_sub_f32 v20, v20, v48
    v_sub_f32 v21, v21, v48
    v_sub_f32 v22, v22, v48
    v_sub_f32 v23, v23, v48
    v_sub_f32 v24, v24, v48
    v_sub_f32 v25, v25, v48
    v_sub_f32 v26, v26, v48
    v_sub_f32 v27, v27, v48
    v_mul_f32 v49, v20, v20
    v_fmac_f32 v49, v21, v21
    v_fmac_f32 v49, v22, v22
    v_fmac_f32 v49, v23, v23
    v_fmac_f32 v49, v24, v24
    v_fmac_f32 v49, v25, v25
    v_fmac_f32 v49, v26, v26
    v_fmac_f32 v49, v27, v27
    v_cmp_gt_u32 vcc, 896, v14
    s_nop 1
    v_cndmask_b32 v49, 0, v49, vcc
    s_nop 1
    v_add_f32_dpp v49, v49, v49 row_ror:8 row_mask:0xf bank_mask:0xf
    s_nop 1
    v_add_f32_dpp v49, v49, v49 row_ror:4 row_mask:0xf bank_mask:0xf
    s_nop 1
    v_add_f32_dpp v49, v49, v49 row_ror:2 row_mask:0xf bank_mask:0xf
    s_nop 1
    v_add_f32_dpp v49, v49, v49 row_ror:1 row_mask:0xf bank_mask:0xf
    s_nop 0
    v_readlane_b32 s68, v49, 0
    v_readlane_b32 s69, v49, 16
    v_readlane_b32 s70, v49, 32
    v_readlane_b32 s71, v49, 48
    s_nop 1
    v_mov_b32 v49, s68
    v_add_f32 v49, s69, v49
    v_add_f32 v49, s70, v49
    v_add_f32 v49, s71, v49
    v_mul_f32 v49, 0x3b124925, v49
    v_cvt_pk_bf16_f32 v48, v48, v48
    v_and_b32 v48, 0xffff0000, v48
    v_cvt_pk_bf16_f32 v49, v49, v49
    v_and_b32 v49, 0xffff0000, v49
    v_add_f32 v49, 0x3727c5ac, v49
    v_cvt_pk_bf16_f32 v49, v49, v49
    v_and_b32 v49, 0xffff0000, v49
    v_sqrt_f32 v49, v49
    s_nop 0
    v_cvt_pk_bf16_f32 v49, v49, v49
    v_and_b32 v49, 0xffff0000, v49
    v_rcp_f32 v49, v49
    v_lshlrev_b32 v12, 16, v12
    v_sub_f32 v12, v12, v48
    v_cvt_pk_bf16_f32 v12, v12, v12
    v_and_b32 v12, 0xffff0000, v12
    v_mul_f32 v12, v12, v49
    v_cvt_pk_bf16_f32 v12, v12, v12
    s_nop 0
    v_and_b32_dpp v16, v12, v4 row_newbcast:0 row_mask:0xf bank_mask:0x3
    v_and_b32_dpp v17, v12, v5 row_newbcast:0 row_mask:0xf bank_mask:0x3
    v_and_b32_dpp v18, v12, v6 row_newbcast:0 row_mask:0xf bank_mask:0x3
    v_and_b32_dpp v19, v12, v7 row_newbcast:0 row_mask:0xf bank_mask:0x3
    v_and_b32_dpp v16, v12, v4 row_newbcast:1 row_mask:0xf bank_mask:0xc
    v_and_b32_dpp v17, v12, v5 row_newbcast:1 row_mask:0xf bank_mask:0xc
    v_and_b32_dpp v18, v12, v6 row_newbcast:1 row_mask:0xf bank_mask:0xc
    v_and_b32_dpp v19, v12, v7 row_newbcast:1 row_mask:0xf bank_mask:0xc
    s_waitcnt vmcnt(18)
    s_nop 0
    v_mfma_f32_16x16x32_bf16 v[20:23], v[16:19], v[56:59], 0
    v_and_b32_dpp v16, v12, v4 row_newbcast:2 row_mask:0xf bank_mask:0x3
    v_and_b32_dpp v17, v12, v5 row_newbcast:2 row_mask:0xf bank_mask:0x3
    v_and_b32_dpp v18, v12, v6 row_newbcast:2 row_mask:0xf bank_mask:0x3
    v_and_b32_dpp v19, v12, v7 row_newbcast:2 row_mask:0xf bank_mask:0x3
    v_and_b32_dpp v16, v12, v4 row_newbcast:3 row_mask:0xf bank_mask:0xc
    v_and_b32_dpp v17, v12, v5 row_newbcast:3 row_mask:0xf bank_mask:0xc
    v_and_b32_dpp v18, v12, v6 row_newbcast:3 row_mask:0xf bank_mask:0xc
    v_and_b32_dpp v19, v12, v7 row_newbcast:3 row_mask:0xf bank_mask:0xc
    s_waitcnt vmcnt(17)
    s_nop 0
    v_mfma_f32_16x16x32_bf16 v[20:23], v[16:19], v[60:63], v[20:23]
    v_and_b32_dpp v16, v12, v4 row_newbcast:4 row_mask:0xf bank_mask:0x3
    v_and_b32_dpp v17, v12, v5 row_newbcast:4 row_mask:0xf bank_mask:0x3
    v_and_b32_dpp v18, v12, v6 row_newbcast:4 row_mask:0xf bank_mask:0x3
    v_and_b32_dpp v19, v12, v7 row_newbcast:4 row_mask:0xf bank_mask:0x3
    v_and_b32_dpp v16, v12, v4 row_newbcast:5 row_mask:0xf bank_mask:0xc
    v_and_b32_dpp v17, v12, v5 row_newbcast:5 row_mask:0xf bank_mask:0xc
    v_and_b32_dpp v18, v12, v6 row_newbcast:5 row_mask:0xf bank_mask:0xc
    v_and_b32_dpp v19, v12, v7 row_newbcast:5 row_mask:0xf bank_mask:0xc
    s_waitcnt vmcnt(16)
    s_nop 0
    v_mfma_f32_16x16x32_bf16 v[20:23], v[16:19], v[64:67], v[20:23]
    v_and_b32_dpp v16, v12, v4 row_newbcast:6 row_mask:0xf bank_mask:0x3
    v_and_b32_dpp v17, v12, v5 row_newbcast:6 row_mask:0xf bank_mask:0x3
    v_and_b32_dpp v18, v12, v6 row_newbcast:6 row_mask:0xf bank_mask:0x3
    v_and_b32_dpp v19, v12, v7 row_newbcast:6 row_mask:0xf bank_mask:0x3
    v_and_b32_dpp v16, v12, v4 row_newbcast:7 row_mask:0xf bank_mask:0xc
    v_and_b32_dpp v17, v12, v5 row_newbcast:7 row_mask:0xf bank_mask:0xc
    v_and_b32_dpp v18, v12, v6 row_newbcast:7 row_mask:0xf bank_mask:0xc
    v_and_b32_dpp v19, v12, v7 row_newbcast:7 row_mask:0xf bank_mask:0xc
    s_waitcnt vmcnt(15)
    s_nop 0
    v_mfma_f32_16x16x32_bf16 v[20:23], v[16:19], v[68:71], v[20:23]
    v_and_b32_dpp v16, v12, v4 row_newbcast:8 row_mask:0xf bank_mask:0x3
    v_and_b32_dpp v17, v12, v5 row_newbcast:8 row_mask:0xf bank_mask:0x3
    v_and_b32_dpp v18, v12, v6 row_newbcast:8 row_mask:0xf bank_mask:0x3
    v_and_b32_dpp v19, v12, v7 row_newbcast:8 row_mask:0xf bank_mask:0x3
    v_and_b32_dpp v16, v12, v4 row_newbcast:9 row_mask:0xf bank_mask:0xc
    v_and_b32_dpp v17, v12, v5 row_newbcast:9 row_mask:0xf bank_mask:0xc
    v_and_b32_dpp v18, v12, v6 row_newbcast:9 row_mask:0xf bank_mask:0xc
    v_and_b32_dpp v19, v12, v7 row_newbcast:9 row_mask:0xf bank_mask:0xc
    s_waitcnt vmcnt(14)
    s_nop 0
    v_mfma_f32_16x16x32_bf16 v[20:23], v[16:19], v[72:75], v[20:23]
    v_and_b32_dpp v16, v12, v4 row_newbcast:10 row_mask:0xf bank_mask:0x3
    v_and_b32_dpp v17, v12, v5 row_newbcast:10 row_mask:0xf bank_mask:0x3
    v_and_b32_dpp v18, v12, v6 row_newbcast:10 row_mask:0xf bank_mask:0x3
    v_and_b32_dpp v19, v12, v7 row_newbcast:10 row_mask:0xf bank_mask:0x3
    v_and_b32_dpp v16, v12, v4 row_newbcast:11 row_mask:0xf bank_mask:0xc
    v_and_b32_dpp v17, v12, v5 row_newbcast:11 row_mask:0xf bank_mask:0xc
    v_and_b32_dpp v18, v12, v6 row_newbcast:11 row_mask:0xf bank_mask:0xc
    v_and_b32_dpp v19, v12, v7 row_newbcast:11 row_mask:0xf bank_mask:0xc
    s_waitcnt vmcnt(13)
    s_nop 0
    v_mfma_f32_16x16x32_bf16 v[20:23], v[16:19], v[76:79], v[20:23]
    v_and_b32_dpp v16, v12, v4 row_newbcast:12 row_mask:0xf bank_mask:0x3
    v_and_b32_dpp v17, v12, v5 row_newbcast:12 row_mask:0xf bank_mask:0x3
    v_and_b32_dpp v18, v12, v6 row_newbcast:12 row_mask:0xf bank_mask:0x3
    v_and_b32_dpp v19, v12, v7 row_newbcast:12 row_mask:0xf bank_mask:0x3
    v_and_b32_dpp v16, v12, v4 row_newbcast:13 row_mask:0xf bank_mask:0xc
    v_and_b32_dpp v17, v12, v5 row_newbcast:13 row_mask:0xf bank_mask:0xc
    v_and_b32_dpp v18, v12, v6 row_newbcast:13 row_mask:0xf bank_mask:0xc
    v_and_b32_dpp v19, v12, v7 row_newbcast:13 row_mask:0xf bank_mask:0xc
    s_waitcnt vmcnt(12)
    s_nop 0
    v_mfma_f32_16x16x32_bf16 v[20:23], v[16:19], v[80:83], v[20:23]
    s_waitcnt vmcnt(10)
    s_mov_b32 s3, 256
    v_mul_lo_u32 v48, v55, s3
    v_add_u32 v48, v48, v54
    s_nop 5
    s_mov_b64 exec, s[56:57]
    ds_write_b128 v48, v[20:23] offset:0
    s_mov_b64 exec, -1
    s_waitcnt lgkmcnt(0)
    v_mov_b32 v48, 25664
    v_mov_b32 v49, 1
    s_mov_b64 exec, 1
    ds_add_u32 v48, v49 offset:0
    s_mov_b64 exec, -1
    s_cmp_eq_u32 s31, 0
    s_cbranch_scc1 L_q_h0
    s_cmp_ge_u32 s15, 56
    s_cbranch_scc1 L_q_done
    s_cmp_eq_u32 s31, 5
    s_cbranch_scc1 L_q_done
    s_cmp_ge_u32 s31, 6
    s_cbranch_scc1 L_f_a
    s_waitcnt vmcnt(7)
    v_mov_b32 v8, v112
    v_mov_b32 v9, v113
    v_mov_b32 v10, v114
    v_mov_b32 v11, v115
    v_lshlrev_b32 v20, 16, v8
    v_and_b32 v21, 0xffff0000, v8
    v_lshlrev_b32 v22, 16, v9
    v_and_b32 v23, 0xffff0000, v9
    v_lshlrev_b32 v24, 16, v10
    v_and_b32 v25, 0xffff0000, v10
    v_lshlrev_b32 v26, 16, v11
    v_and_b32 v27, 0xffff0000, v11
    v_add_f32 v48, v20, v21
    v_add_f32 v48, v48, v22
    v_add_f32 v48, v48, v23
    v_add_f32 v48, v48, v24
    v_add_f32 v48, v48, v25
    v_add_f32 v48, v48, v26
    v_add_f32 v48, v48, v27
    s_nop 1
    v_add_f32_dpp v48, v48, v48 row_ror:8 row_mask:0xf bank_mask:0xf
    s_nop 1
    v_add_f32_dpp v48, v48, v48 row_ror:4 row_mask:0xf bank_mask:0xf
    s_nop 1
    v_add_f32_dpp v48, v48, v48 row_ror:2 row_mask:0xf bank_mask:0xf
    s_nop 1
    v_add_f32_dpp v48, v48, v48 row_ror:1 row_mask:0xf bank_mask:0xf
    s_nop 0
    v_readlane_b32 s68, v48, 0
    v_readlane_b32 s69, v48, 16
    v_readlane_b32 s70, v48, 32
    v_readlane_b32 s71, v48, 48
    s_nop 1
    v_mov_b32 v48, s68
    v_add_f32 v48, s69, v48
    v_add_f32 v48, s70, v48
    v_add_f32 v48, s71, v48
    v_mul_f32 v48, 0x3b124925, v48
    v_sub_f32 v20, v20, v48
    v_sub_f32 v21, v21, v48
    v_sub_f32 v22, v22, v48
    v_sub_f32 v23, v23, v48
    v_sub_f32 v24, v24, v48
    v_sub_f32 v25, v25, v48
    v_sub_f32 v26, v26, v48
    v_sub_f32 v27, v27, v48
    v_mul_f32 v49, v20, v20
    v_fmac_f32 v49, v21, v21
    v_fmac_f32 v49, v22, v22
    v_fmac_f32 v49, v23, v23
    v_fmac_f32 v49, v24, v24
    v_fmac_f32 v49, v25, v25
    v_fmac_f32 v49, v26, v26
    v_fmac_f32 v49, v27, v27
    v_cmp_gt_u32 vcc, 896, v14
    s_nop 1
    v_cndmask_b32 v49, 0, v49, vcc
    s_nop 1
    v_add_f32_dpp v49, v49, v49 row_ror:8 row_mask:0xf bank_mask:0xf
    s_nop 1
    v_add_f32_dpp v49, v49, v49 row_ror:4 row_mask:0xf bank_mask:0xf
    s_nop 1
    v_add_f32_dpp v49, v49, v49 row_ror:2 row_mask:0xf bank_mask:0xf
    s_nop 1
    v_add_f32_dpp v49, v49, v49 row_ror:1 row_mask:0xf bank_mask:0xf
    s_nop 0
    v_readlane_b32 s68, v49, 0
    v_readlane_b32 s69, v49, 16
    v_readlane_b32 s70, v49, 32
    v_readlane_b32 s71, v49, 48
    s_nop 1
    v_mov_b32 v49, s68
    v_add_f32 v49, s69, v49
    v_add_f32 v49, s70, v49
    v_add_f32 v49, s71, v49
    v_mul_f32 v49, 0x3b124925, v49
    v_cvt_pk_bf16_f32 v48, v48, v48
    v_and_b32 v48, 0xffff0000, v48
    v_cvt_pk_bf16_f32 v49, v49, v49
    v_and_b32 v49, 0xffff0000, v49
    v_add_f32 v49, 0x3727c5ac, v49
    v_cvt_pk_bf16_f32 v49, v49, v49
    v_and_b32 v49, 0xffff0000, v49
    v_sqrt_f32 v49, v49
    s_nop 0
    v_cvt_pk_bf16_f32 v49, v49, v49
    v_and_b32 v49, 0xffff0000, v49
    v_rcp_f32 v49, v49
    v_lshlrev_b32 v116, 16, v116
    v_sub_f32 v116, v116, v48
    v_cvt_pk_bf16_f32 v116, v116, v116
    v_and_b32 v116, 0xffff0000, v116
    v_lshlrev_b32 v117, 16, v117
    v_sub_f32 v117, v117, v48
    v_cvt_pk_bf16_f32 v117, v117, v117
    v_and_b32 v117, 0xffff0000, v117
    v_mul_f32 v116, v116, v49
    v_mul_f32 v117, v117, v49
    v_cvt_pk_bf16_f32 v116, v116, v116
    v_cvt_pk_bf16_f32 v117, v117, v117
    s_and_b32 s3, s31, 3
    s_lshl_b32 s3, s3, 8
    v_lshrrev_b32 v50, 2, v14
    v_add_u32 v50, s3, v50
    ds_write_b32 v50, v116 offset:4096
    ds_write_b32 v50, v117 offset:5120
    s_waitcnt lgkmcnt(0)
    v_mov_b32 v48, 25664
    v_mov_b32 v49, 1
    s_mov_b64 exec, 1
    ds_add_u32 v48, v49 offset:8
    s_mov_b64 exec, -1
    s_branch L_q_done
L_f_a:
    s_lshl_b32 s3, s61, 13
    s_lshl_b32 s63, s60, 10
    s_add_u32 s3, s3, s63
    s_add_u32 s3, s3, 1572864
    s_add_u32 s36, s26, s3
    s_addc_u32 s37, s27, 0
    s_mov_b32 s38, 1024
    s_and_b32 s63, s31, 1
    s_lshl_b32 s63, s63, 10
    v_lshrrev_b32 v50, 2, v14
    v_add_u32 v50, s63, v50
HB_19:
    ds_read_b32 v49, v48 offset:8
    s_waitcnt lgkmcnt(0)
    v_readfirstlane_b32 s3, v49
    s_cmp_lt_u32 s3, 4
    s_cbranch_scc1 HB_19
    ds_read_b32 v8, v50 offset:4096
    ds_read_b32 v9, v50 offset:4352
    ds_read_b32 v10, v50 offset:4608
    ds_read_b32 v11, v50 offset:4864
    s_waitcnt vmcnt(0) lgkmcnt(0)
    s_nop 0
    v_and_b32_dpp v16, v8, v4 row_newbcast:0 row_mask:0xf bank_mask:0x3
    v_and_b32_dpp v17, v8, v5 row_newbcast:0 row_mask:0xf bank_mask:0x3
    v_and_b32_dpp v18, v8, v6 row_newbcast:0 row_mask:0xf bank_mask:0x3
    v_and_b32_dpp v19, v8, v7 row_newbcast:0 row_mask:0xf bank_mask:0x3
    v_and_b32_dpp v16, v8, v4 row_newbcast:1 row_mask:0xf bank_mask:0xc
    v_and_b32_dpp v17, v8, v5 row_newbcast:1 row_mask:0xf bank_mask:0xc
    v_and_b32_dpp v18, v8, v6 row_newbcast:1 row_mask:0xf bank_mask:0xc
    v_and_b32_dpp v19, v8, v7 row_newbcast:1 row_mask:0xf bank_mask:0xc
    s_nop 1
    v_mfma_f32_16x16x32_bf16 v[20:23], v[16:19], v[84:87], 0
    v_and_b32_dpp v16, v9, v4 row_newbcast:0 row_mask:0xf bank_mask:0x3
    v_and_b32_dpp v17, v9, v5 row_newbcast:0 row_mask:0xf bank_mask:0x3
    v_and_b32_dpp v18, v9, v6 row_newbcast:0 row_mask:0xf bank_mask:0x3
    v_and_b32_dpp v19, v9, v7 row_newbcast:0 row_mask:0xf bank_mask:0x3
    v_and_b32_dpp v16, v9, v4 row_newbcast:1 row_mask:0xf bank_mask:0xc
    v_and_b32_dpp v17, v9, v5 row_newbcast:1 row_mask:0xf bank_mask:0xc
    v_and_b32_dpp v18, v9, v6 row_newbcast:1 row_mask:0xf bank_mask:0xc
    v_and_b32_dpp v19, v9, v7 row_newbcast:1 row_mask:0xf bank_mask:0xc
    s_nop 1
    v_mfma_f32_16x16x32_bf16 v[24:27], v[16:19], v[84:87], 0
    v_and_b32_dpp v16, v10, v4 row_newbcast:0 row_mask:0xf bank_mask:0x3
    v_and_b32_dpp v17, v10, v5 row_newbcast:0 row_mask:0xf bank_mask:0x3
    v_and_b32_dpp v18, v10, v6 row_newbcast:0 row_mask:0xf bank_mask:0x3
    v_and_b32_dpp v19, v10, v7 row_newbcast:0 row_mask:0xf bank_mask:0x3
    v_and_b32_dpp v16, v10, v4 row_newbcast:1 row_mask:0xf bank_mask:0xc
    v_and_b32_dpp v17, v10, v5 row_newbcast:1 row_mask:0xf bank_mask:0xc
    v_and_b32_dpp v18, v10, v6 row_newbcast:1 row_mask:0xf bank_mask:0xc
    v_and_b32_dpp v19, v10, v7 row_newbcast:1 row_mask:0xf bank_mask:0xc
    s_nop 1
    v_mfma_f32_16x16x32_bf16 v[28:31], v[16:19], v[84:87], 0
    v_and_b32_dpp v16, v11, v4 row_newbcast:0 row_mask:0xf bank_mask:0x3
    v_and_b32_dpp v17, v11, v5 row_newbcast:0 row_mask:0xf bank_mask:0x3
    v_and_b32_dpp v18, v11, v6 row_newbcast:0 row_mask:0xf bank_mask:0x3
    v_and_b32_dpp v19, v11, v7 row_newbcast:0 row_mask:0xf bank_mask:0x3
    v_and_b32_dpp v16, v11, v4 row_newbcast:1 row_mask:0xf bank_mask:0xc
    v_and_b32_dpp v17, v11, v5 row_newbcast:1 row_mask:0xf bank_mask:0xc
    v_and_b32_dpp v18, v11, v6 row_newbcast:1 row_mask:0xf bank_mask:0xc
    v_and_b32_dpp v19, v11, v7 row_newbcast:1 row_mask:0xf bank_mask:0xc
    s_nop 1
    v_mfma_f32_16x16x32_bf16 v[32:35], v[16:19], v[84:87], 0
    v_and_b32_dpp v16, v8, v4 row_newbcast:2 row_mask:0xf bank_mask:0x3
    v_and_b32_dpp v17, v8, v5 row_newbcast:2 row_mask:0xf bank_mask:0x3
    v_and_b32_dpp v18, v8, v6 row_newbcast:2 row_mask:0xf bank_mask:0x3
    v_and_b32_dpp v19, v8, v7 row_newbcast:2 row_mask:0xf bank_mask:0x3
    v_and_b32_dpp v16, v8, v4 row_newbcast:3 row_mask:0xf bank_mask:0xc
    v_and_b32_dpp v17, v8, v5 row_newbcast:3 row_mask:0xf bank_mask:0xc
    v_and_b32_dpp v18, v8, v6 row_newbcast:3 row_mask:0xf bank_mask:0xc
    v_and_b32_dpp v19, v8, v7 row_newbcast:3 row_mask:0xf bank_mask:0xc
    s_nop 1
    v_mfma_f32_16x16x32_bf16 v[20:23], v[16:19], v[88:91], v[20:23]
    v_and_b32_dpp v16, v9, v4 row_newbcast:2 row_mask:0xf bank_mask:0x3
    v_and_b32_dpp v17, v9, v5 row_newbcast:2 row_mask:0xf bank_mask:0x3
    v_and_b32_dpp v18, v9, v6 row_newbcast:2 row_mask:0xf bank_mask:0x3
    v_and_b32_dpp v19, v9, v7 row_newbcast:2 row_mask:0xf bank_mask:0x3
    v_and_b32_dpp v16, v9, v4 row_newbcast:3 row_mask:0xf bank_mask:0xc
    v_and_b32_dpp v17, v9, v5 row_newbcast:3 row_mask:0xf bank_mask:0xc
    v_and_b32_dpp v18, v9, v6 row_newbcast:3 row_mask:0xf bank_mask:0xc
    v_and_b32_dpp v19, v9, v7 row_newbcast:3 row_mask:0xf bank_mask:0xc
    s_nop 1
    v_mfma_f32_16x16x32_bf16 v[24:27], v[16:19], v[88:91], v[24:27]
    v_and_b32_dpp v16, v10, v4 row_newbcast:2 row_mask:0xf bank_mask:0x3
    v_and_b32_dpp v17, v10, v5 row_newbcast:2 row_mask:0xf bank_mask:0x3
    v_and_b32_dpp v18, v10, v6 row_newbcast:2 row_mask:0xf bank_mask:0x3
    v_and_b32_dpp v19, v10, v7 row_newbcast:2 row_mask:0xf bank_mask:0x3
    v_and_b32_dpp v16, v10, v4 row_newbcast:3 row_mask:0xf bank_mask:0xc
    v_and_b32_dpp v17, v10, v5 row_newbcast:3 row_mask:0xf bank_mask:0xc
    v_and_b32_dpp v18, v10, v6 row_newbcast:3 row_mask:0xf bank_mask:0xc
    v_and_b32_dpp v19, v10, v7 row_newbcast:3 row_mask:0xf bank_mask:0xc
    s_nop 1
    v_mfma_f32_16x16x32_bf16 v[28:31], v[16:19], v[88:91], v[28:31]
    v_and_b32_dpp v16, v11, v4 row_newbcast:2 row_mask:0xf bank_mask:0x3
    v_and_b32_dpp v17, v11, v5 row_newbcast:2 row_mask:0xf bank_mask:0x3
    v_and_b32_dpp v18, v11, v6 row_newbcast:2 row_mask:0xf bank_mask:0x3
    v_and_b32_dpp v19, v11, v7 row_newbcast:2 row_mask:0xf bank_mask:0x3
    v_and_b32_dpp v16, v11, v4 row_newbcast:3 row_mask:0xf bank_mask:0xc
    v_and_b32_dpp v17, v11, v5 row_newbcast:3 row_mask:0xf bank_mask:0xc
    v_and_b32_dpp v18, v11, v6 row_newbcast:3 row_mask:0xf bank_mask:0xc
    v_and_b32_dpp v19, v11, v7 row_newbcast:3 row_mask:0xf bank_mask:0xc
    s_nop 1
    v_mfma_f32_16x16x32_bf16 v[32:35], v[16:19], v[88:91], v[32:35]
    v_and_b32_dpp v16, v8, v4 row_newbcast:4 row_mask:0xf bank_mask:0x3
    v_and_b32_dpp v17, v8, v5 row_newbcast:4 row_mask:0xf bank_mask:0x3
    v_and_b32_dpp v18, v8, v6 row_newbcast:4 row_mask:0xf bank_mask:0x3
    v_and_b32_dpp v19, v8, v7 row_newbcast:4 row_mask:0xf bank_mask:0x3
    v_and_b32_dpp v16, v8, v4 row_newbcast:5 row_mask:0xf bank_mask:0xc
    v_and_b32_dpp v17, v8, v5 row_newbcast:5 row_mask:0xf bank_mask:0xc
    v_and_b32_dpp v18, v8, v6 row_newbcast:5 row_mask:0xf bank_mask:0xc
    v_and_b32_dpp v19, v8, v7 row_newbcast:5 row_mask:0xf bank_mask:0xc
    s_nop 1
    v_mfma_f32_16x16x32_bf16 v[20:23], v[16:19], v[92:95], v[20:23]
    v_and_b32_dpp v16, v9, v4 row_newbcast:4 row_mask:0xf bank_mask:0x3
    v_and_b32_dpp v17, v9, v5 row_newbcast:4 row_mask:0xf bank_mask:0x3
    v_and_b32_dpp v18, v9, v6 row_newbcast:4 row_mask:0xf bank_mask:0x3
    v_and_b32_dpp v19, v9, v7 row_newbcast:4 row_mask:0xf bank_mask:0x3
    v_and_b32_dpp v16, v9, v4 row_newbcast:5 row_mask:0xf bank_mask:0xc
    v_and_b32_dpp v17, v9, v5 row_newbcast:5 row_mask:0xf bank_mask:0xc
    v_and_b32_dpp v18, v9, v6 row_newbcast:5 row_mask:0xf bank_mask:0xc
    v_and_b32_dpp v19, v9, v7 row_newbcast:5 row_mask:0xf bank_mask:0xc
    s_nop 1
    v_mfma_f32_16x16x32_bf16 v[24:27], v[16:19], v[92:95], v[24:27]
    v_and_b32_dpp v16, v10, v4 row_newbcast:4 row_mask:0xf bank_mask:0x3
    v_and_b32_dpp v17, v10, v5 row_newbcast:4 row_mask:0xf bank_mask:0x3
    v_and_b32_dpp v18, v10, v6 row_newbcast:4 row_mask:0xf bank_mask:0x3
    v_and_b32_dpp v19, v10, v7 row_newbcast:4 row_mask:0xf bank_mask:0x3
    v_and_b32_dpp v16, v10, v4 row_newbcast:5 row_mask:0xf bank_mask:0xc
    v_and_b32_dpp v17, v10, v5 row_newbcast:5 row_mask:0xf bank_mask:0xc
    v_and_b32_dpp v18, v10, v6 row_newbcast:5 row_mask:0xf bank_mask:0xc
    v_and_b32_dpp v19, v10, v7 row_newbcast:5 row_mask:0xf bank_mask:0xc
    s_nop 1
    v_mfma_f32_16x16x32_bf16 v[28:31], v[16:19], v[92:95], v[28:31]
    v_and_b32_dpp v16, v11, v4 row_newbcast:4 row_mask:0xf bank_mask:0x3
    v_and_b32_dpp v17, v11, v5 row_newbcast:4 row_mask:0xf bank_mask:0x3
    v_and_b32_dpp v18, v11, v6 row_newbcast:4 row_mask:0xf bank_mask:0x3
    v_and_b32_dpp v19, v11, v7 row_newbcast:4 row_mask:0xf bank_mask:0x3
    v_and_b32_dpp v16, v11, v4 row_newbcast:5 row_mask:0xf bank_mask:0xc
    v_and_b32_dpp v17, v11, v5 row_newbcast:5 row_mask:0xf bank_mask:0xc
    v_and_b32_dpp v18, v11, v6 row_newbcast:5 row_mask:0xf bank_mask:0xc
    v_and_b32_dpp v19, v11, v7 row_newbcast:5 row_mask:0xf bank_mask:0xc
    s_nop 1
    v_mfma_f32_16x16x32_bf16 v[32:35], v[16:19], v[92:95], v[32:35]
    v_and_b32_dpp v16, v8, v4 row_newbcast:6 row_mask:0xf bank_mask:0x3
    v_and_b32_dpp v17, v8, v5 row_newbcast:6 row_mask:0xf bank_mask:0x3
    v_and_b32_dpp v18, v8, v6 row_newbcast:6 row_mask:0xf bank_mask:0x3
    v_and_b32_dpp v19, v8, v7 row_newbcast:6 row_mask:0xf bank_mask:0x3
    v_and_b32_dpp v16, v8, v4 row_newbcast:7 row_mask:0xf bank_mask:0xc
    v_and_b32_dpp v17, v8, v5 row_newbcast:7 row_mask:0xf bank_mask:0xc
    v_and_b32_dpp v18, v8, v6 row_newbcast:7 row_mask:0xf bank_mask:0xc
    v_and_b32_dpp v19, v8, v7 row_newbcast:7 row_mask:0xf bank_mask:0xc
    s_nop 1
    v_mfma_f32_16x16x32_bf16 v[20:23], v[16:19], v[96:99], v[20:23]
    v_and_b32_dpp v16, v9, v4 row_newbcast:6 row_mask:0xf bank_mask:0x3
    v_and_b32_dpp v17, v9, v5 row_newbcast:6 row_mask:0xf bank_mask:0x3
    v_and_b32_dpp v18, v9, v6 row_newbcast:6 row_mask:0xf bank_mask:0x3
    v_and_b32_dpp v19, v9, v7 row_newbcast:6 row_mask:0xf bank_mask:0x3
    v_and_b32_dpp v16, v9, v4 row_newbcast:7 row_mask:0xf bank_mask:0xc
    v_and_b32_dpp v17, v9, v5 row_newbcast:7 row_mask:0xf bank_mask:0xc
    v_and_b32_dpp v18, v9, v6 row_newbcast:7 row_mask:0xf bank_mask:0xc
    v_and_b32_dpp v19, v9, v7 row_newbcast:7 row_mask:0xf bank_mask:0xc
    s_nop 1
    v_mfma_f32_16x16x32_bf16 v[24:27], v[16:19], v[96:99], v[24:27]
    v_and_b32_dpp v16, v10, v4 row_newbcast:6 row_mask:0xf bank_mask:0x3
    v_and_b32_dpp v17, v10, v5 row_newbcast:6 row_mask:0xf bank_mask:0x3
    v_and_b32_dpp v18, v10, v6 row_newbcast:6 row_mask:0xf bank_mask:0x3
    v_and_b32_dpp v19, v10, v7 row_newbcast:6 row_mask:0xf bank_mask:0x3
    v_and_b32_dpp v16, v10, v4 row_newbcast:7 row_mask:0xf bank_mask:0xc
    v_and_b32_dpp v17, v10, v5 row_newbcast:7 row_mask:0xf bank_mask:0xc
    v_and_b32_dpp v18, v10, v6 row_newbcast:7 row_mask:0xf bank_mask:0xc
    v_and_b32_dpp v19, v10, v7 row_newbcast:7 row_mask:0xf bank_mask:0xc
    s_nop 1
    v_mfma_f32_16x16x32_bf16 v[28:31], v[16:19], v[96:99], v[28:31]
    v_and_b32_dpp v16, v11, v4 row_newbcast:6 row_mask:0xf bank_mask:0x3
    v_and_b32_dpp v17, v11, v5 row_newbcast:6 row_mask:0xf bank_mask:0x3
    v_and_b32_dpp v18, v11, v6 row_newbcast:6 row_mask:0xf bank_mask:0x3
    v_and_b32_dpp v19, v11, v7 row_newbcast:6 row_mask:0xf bank_mask:0x3
    v_and_b32_dpp v16, v11, v4 row_newbcast:7 row_mask:0xf bank_mask:0xc
    v_and_b32_dpp v17, v11, v5 row_newbcast:7 row_mask:0xf bank_mask:0xc
    v_and_b32_dpp v18, v11, v6 row_newbcast:7 row_mask:0xf bank_mask:0xc
    v_and_b32_dpp v19, v11, v7 row_newbcast:7 row_mask:0xf bank_mask:0xc
    s_nop 1
    v_mfma_f32_16x16x32_bf16 v[32:35], v[16:19], v[96:99], v[32:35]
    v_and_b32_dpp v16, v8, v4 row_newbcast:8 row_mask:0xf bank_mask:0x3
    v_and_b32_dpp v17, v8, v5 row_newbcast:8 row_mask:0xf bank_mask:0x3
    v_and_b32_dpp v18, v8, v6 row_newbcast:8 row_mask:0xf bank_mask:0x3
    v_and_b32_dpp v19, v8, v7 row_newbcast:8 row_mask:0xf bank_mask:0x3
    v_and_b32_dpp v16, v8, v4 row_newbcast:9 row_mask:0xf bank_mask:0xc
    v_and_b32_dpp v17, v8, v5 row_newbcast:9 row_mask:0xf bank_mask:0xc
    v_and_b32_dpp v18, v8, v6 row_newbcast:9 row_mask:0xf bank_mask:0xc
    v_and_b32_dpp v19, v8, v7 row_newbcast:9 row_mask:0xf bank_mask:0xc
    s_nop 1
    v_mfma_f32_16x16x32_bf16 v[20:23], v[16:19], v[100:103], v[20:23]
    v_and_b32_dpp v16, v9, v4 row_newbcast:8 row_mask:0xf bank_mask:0x3
    v_and_b32_dpp v17, v9, v5 row_newbcast:8 row_mask:0xf bank_mask:0x3
    v_and_b32_dpp v18, v9, v6 row_newbcast:8 row_mask:0xf bank_mask:0x3
    v_and_b32_dpp v19, v9, v7 row_newbcast:8 row_mask:0xf bank_mask:0x3
    v_and_b32_dpp v16, v9, v4 row_newbcast:9 row_mask:0xf bank_mask:0xc
    v_and_b32_dpp v17, v9, v5 row_newbcast:9 row_mask:0xf bank_mask:0xc
    v_and_b32_dpp v18, v9, v6 row_newbcast:9 row_mask:0xf bank_mask:0xc
    v_and_b32_dpp v19, v9, v7 row_newbcast:9 row_mask:0xf bank_mask:0xc
    s_nop 1
    v_mfma_f32_16x16x32_bf16 v[24:27], v[16:19], v[100:103], v[24:27]
    v_and_b32_dpp v16, v10, v4 row_newbcast:8 row_mask:0xf bank_mask:0x3
    v_and_b32_dpp v17, v10, v5 row_newbcast:8 row_mask:0xf bank_mask:0x3
    v_and_b32_dpp v18, v10, v6 row_newbcast:8 row_mask:0xf bank_mask:0x3
    v_and_b32_dpp v19, v10, v7 row_newbcast:8 row_mask:0xf bank_mask:0x3
    v_and_b32_dpp v16, v10, v4 row_newbcast:9 row_mask:0xf bank_mask:0xc
    v_and_b32_dpp v17, v10, v5 row_newbcast:9 row_mask:0xf bank_mask:0xc
    v_and_b32_dpp v18, v10, v6 row_newbcast:9 row_mask:0xf bank_mask:0xc
    v_and_b32_dpp v19, v10, v7 row_newbcast:9 row_mask:0xf bank_mask:0xc
    s_nop 1
    v_mfma_f32_16x16x32_bf16 v[28:31], v[16:19], v[100:103], v[28:31]
    v_and_b32_dpp v16, v11, v4 row_newbcast:8 row_mask:0xf bank_mask:0x3
    v_and_b32_dpp v17, v11, v5 row_newbcast:8 row_mask:0xf bank_mask:0x3
    v_and_b32_dpp v18, v11, v6 row_newbcast:8 row_mask:0xf bank_mask:0x3
    v_and_b32_dpp v19, v11, v7 row_newbcast:8 row_mask:0xf bank_mask:0x3
    v_and_b32_dpp v16, v11, v4 row_newbcast:9 row_mask:0xf bank_mask:0xc
    v_and_b32_dpp v17, v11, v5 row_newbcast:9 row_mask:0xf bank_mask:0xc
    v_and_b32_dpp v18, v11, v6 row_newbcast:9 row_mask:0xf bank_mask:0xc
    v_and_b32_dpp v19, v11, v7 row_newbcast:9 row_mask:0xf bank_mask:0xc
    s_nop 1
    v_mfma_f32_16x16x32_bf16 v[32:35], v[16:19], v[100:103], v[32:35]
    v_and_b32_dpp v16, v8, v4 row_newbcast:10 row_mask:0xf bank_mask:0x3
    v_and_b32_dpp v17, v8, v5 row_newbcast:10 row_mask:0xf bank_mask:0x3
    v_and_b32_dpp v18, v8, v6 row_newbcast:10 row_mask:0xf bank_mask:0x3
    v_and_b32_dpp v19, v8, v7 row_newbcast:10 row_mask:0xf bank_mask:0x3
    v_and_b32_dpp v16, v8, v4 row_newbcast:11 row_mask:0xf bank_mask:0xc
    v_and_b32_dpp v17, v8, v5 row_newbcast:11 row_mask:0xf bank_mask:0xc
    v_and_b32_dpp v18, v8, v6 row_newbcast:11 row_mask:0xf bank_mask:0xc
    v_and_b32_dpp v19, v8, v7 row_newbcast:11 row_mask:0xf bank_mask:0xc
    s_nop 1
    v_mfma_f32_16x16x32_bf16 v[20:23], v[16:19], v[104:107], v[20:23]
    v_and_b32_dpp v16, v9, v4 row_newbcast:10 row_mask:0xf bank_mask:0x3
    v_and_b32_dpp v17, v9, v5 row_newbcast:10 row_mask:0xf bank_mask:0x3
    v_and_b32_dpp v18, v9, v6 row_newbcast:10 row_mask:0xf bank_mask:0x3
    v_and_b32_dpp v19, v9, v7 row_newbcast:10 row_mask:0xf bank_mask:0x3
    v_and_b32_dpp v16, v9, v4 row_newbcast:11 row_mask:0xf bank_mask:0xc
    v_and_b32_dpp v17, v9, v5 row_newbcast:11 row_mask:0xf bank_mask:0xc
    v_and_b32_dpp v18, v9, v6 row_newbcast:11 row_mask:0xf bank_mask:0xc
    v_and_b32_dpp v19, v9, v7 row_newbcast:11 row_mask:0xf bank_mask:0xc
    s_nop 1
    v_mfma_f32_16x16x32_bf16 v[24:27], v[16:19], v[104:107], v[24:27]
    v_and_b32_dpp v16, v10, v4 row_newbcast:10 row_mask:0xf bank_mask:0x3
    v_and_b32_dpp v17, v10, v5 row_newbcast:10 row_mask:0xf bank_mask:0x3
    v_and_b32_dpp v18, v10, v6 row_newbcast:10 row_mask:0xf bank_mask:0x3
    v_and_b32_dpp v19, v10, v7 row_newbcast:10 row_mask:0xf bank_mask:0x3
    v_and_b32_dpp v16, v10, v4 row_newbcast:11 row_mask:0xf bank_mask:0xc
    v_and_b32_dpp v17, v10, v5 row_newbcast:11 row_mask:0xf bank_mask:0xc
    v_and_b32_dpp v18, v10, v6 row_newbcast:11 row_mask:0xf bank_mask:0xc
    v_and_b32_dpp v19, v10, v7 row_newbcast:11 row_mask:0xf bank_mask:0xc
    s_nop 1
    v_mfma_f32_16x16x32_bf16 v[28:31], v[16:19], v[104:107], v[28:31]
    v_and_b32_dpp v16, v11, v4 row_newbcast:10 row_mask:0xf bank_mask:0x3
    v_and_b32_dpp v17, v11, v5 row_newbcast:10 row_mask:0xf bank_mask:0x3
    v_and_b32_dpp v18, v11, v6 row_newbcast:10 row_mask:0xf bank_mask:0x3
    v_and_b32_dpp v19, v11, v7 row_newbcast:10 row_mask:0xf bank_mask:0x3
    v_and_b32_dpp v16, v11, v4 row_newbcast:11 row_mask:0xf bank_mask:0xc
    v_and_b32_dpp v17, v11, v5 row_newbcast:11 row_mask:0xf bank_mask:0xc
    v_and_b32_dpp v18, v11, v6 row_newbcast:11 row_mask:0xf bank_mask:0xc
    v_and_b32_dpp v19, v11, v7 row_newbcast:11 row_mask:0xf bank_mask:0xc
    s_nop 1
    v_mfma_f32_16x16x32_bf16 v[32:35], v[16:19], v[104:107], v[32:35]
    v_and_b32_dpp v16, v8, v4 row_newbcast:12 row_mask:0xf bank_mask:0x3
    v_and_b32_dpp v17, v8, v5 row_newbcast:12 row_mask:0xf bank_mask:0x3
    v_and_b32_dpp v18, v8, v6 row_newbcast:12 row_mask:0xf bank_mask:0x3
    v_and_b32_dpp v19, v8, v7 row_newbcast:12 row_mask:0xf bank_mask:0x3
    v_and_b32_dpp v16, v8, v4 row_newbcast:13 row_mask:0xf bank_mask:0xc
    v_and_b32_dpp v17, v8, v5 row_newbcast:13 row_mask:0xf bank_mask:0xc
    v_and_b32_dpp v18, v8, v6 row_newbcast:13 row_mask:0xf bank_mask:0xc
    v_and_b32_dpp v19, v8, v7 row_newbcast:13 row_mask:0xf bank_mask:0xc
    s_nop 1
    v_mfma_f32_16x16x32_bf16 v[20:23], v[16:19], v[108:111], v[20:23]
    v_and_b32_dpp v16, v9, v4 row_newbcast:12 row_mask:0xf bank_mask:0x3
    v_and_b32_dpp v17, v9, v5 row_newbcast:12 row_mask:0xf bank_mask:0x3
    v_and_b32_dpp v18, v9, v6 row_newbcast:12 row_mask:0xf bank_mask:0x3
    v_and_b32_dpp v19, v9, v7 row_newbcast:12 row_mask:0xf bank_mask:0x3
    v_and_b32_dpp v16, v9, v4 row_newbcast:13 row_mask:0xf bank_mask:0xc
    v_and_b32_dpp v17, v9, v5 row_newbcast:13 row_mask:0xf bank_mask:0xc
    v_and_b32_dpp v18, v9, v6 row_newbcast:13 row_mask:0xf bank_mask:0xc
    v_and_b32_dpp v19, v9, v7 row_newbcast:13 row_mask:0xf bank_mask:0xc
    s_nop 1
    v_mfma_f32_16x16x32_bf16 v[24:27], v[16:19], v[108:111], v[24:27]
    v_and_b32_dpp v16, v10, v4 row_newbcast:12 row_mask:0xf bank_mask:0x3
    v_and_b32_dpp v17, v10, v5 row_newbcast:12 row_mask:0xf bank_mask:0x3
    v_and_b32_dpp v18, v10, v6 row_newbcast:12 row_mask:0xf bank_mask:0x3
    v_and_b32_dpp v19, v10, v7 row_newbcast:12 row_mask:0xf bank_mask:0x3
    v_and_b32_dpp v16, v10, v4 row_newbcast:13 row_mask:0xf bank_mask:0xc
    v_and_b32_dpp v17, v10, v5 row_newbcast:13 row_mask:0xf bank_mask:0xc
    v_and_b32_dpp v18, v10, v6 row_newbcast:13 row_mask:0xf bank_mask:0xc
    v_and_b32_dpp v19, v10, v7 row_newbcast:13 row_mask:0xf bank_mask:0xc
    s_nop 1
    v_mfma_f32_16x16x32_bf16 v[28:31], v[16:19], v[108:111], v[28:31]
    v_and_b32_dpp v16, v11, v4 row_newbcast:12 row_mask:0xf bank_mask:0x3
    v_and_b32_dpp v17, v11, v5 row_newbcast:12 row_mask:0xf bank_mask:0x3
    v_and_b32_dpp v18, v11, v6 row_newbcast:12 row_mask:0xf bank_mask:0x3
    v_and_b32_dpp v19, v11, v7 row_newbcast:12 row_mask:0xf bank_mask:0x3
    v_and_b32_dpp v16, v11, v4 row_newbcast:13 row_mask:0xf bank_mask:0xc
    v_and_b32_dpp v17, v11, v5 row_newbcast:13 row_mask:0xf bank_mask:0xc
    v_and_b32_dpp v18, v11, v6 row_newbcast:13 row_mask:0xf bank_mask:0xc
    v_and_b32_dpp v19, v11, v7 row_newbcast:13 row_mask:0xf bank_mask:0xc
    s_nop 1
    v_mfma_f32_16x16x32_bf16 v[32:35], v[16:19], v[108:111], v[32:35]
    s_mov_b32 s3, 1024
    v_mul_lo_u32 v48, v55, s3
    v_add_u32 v48, v48, v54
    s_nop 5
    s_mov_b64 exec, s[56:57]
    ds_write_b128 v48, v[20:23] offset:0
    ds_write_b128 v48, v[24:27] offset:256
    ds_write_b128 v48, v[28:31] offset:512
    ds_write_b128 v48, v[32:35] offset:768
    s_mov_b64 exec, -1
    s_waitcnt lgkmcnt(0)
    s_cmp_eq_u32 s31, 7
    s_cbranch_scc1 L_f_a7
    v_mov_b32 v48, 25664
    v_mov_b32 v49, 1
    s_mov_b64 exec, 1
    ds_add_u32 v48, v49 offset:8
    s_mov_b64 exec, -1
    s_branch L_q_done
L_f_a7:
    v_mov_b32 v48, 25664
HB_20:
    ds_read_b32 v49, v48 offset:8
    s_waitcnt lgkmcnt(0)
    v_readfirstlane_b32 s3, v49
    s_cmp_lt_u32 s3, 5
    s_cbranch_scc1 HB_20
    ds_read_b128 v[56:59], v14 offset:12288
    ds_read_b128 v[60:63], v14 offset:13312
    ds_read_b128 v[64:67], v14 offset:14336
    ds_read_b128 v[68:71], v14 offset:15360
    s_waitcnt lgkmcnt(0)
    v_add_f32 v56, v56, v64
    v_add_f32 v57, v57, v65
    v_add_f32 v58, v58, v66
    v_add_f32 v59, v59, v67
    v_add_f32 v60, v60, v68
    v_add_f32 v61, v61, v69
    v_add_f32 v62, v62, v70
    v_add_f32 v63, v63, v71
    v_add_f32 v56, v56, v60
    v_add_f32 v57, v57, v61
    v_add_f32 v58, v58, v62
    v_add_f32 v59, v59, v63
    buffer_store_dwordx4 v[56:59], v14, s[36:39], 0 offen sc0 sc1
    s_branch L_q_done
L_q_h0:
    v_lshlrev_b32 v50, 2, v0
HB_21:
    ds_read_b32 v49, v48 offset:0
    s_waitcnt lgkmcnt(0)
    v_readfirstlane_b32 s3, v49
    s_cmp_lt_u32 s3, 8
    s_cbranch_scc1 HB_21
    ds_read_b32 v20, v50 offset:0
    ds_read_b32 v21, v50 offset:256
    ds_read_b32 v22, v50 offset:512
    ds_read_b32 v23, v50 offset:768
    ds_read_b32 v24, v50 offset:1024
    ds_read_b32 v25, v50 offset:1280
    ds_read_b32 v26, v50 offset:1536
    ds_read_b32 v27, v50 offset:1792
    ds_read_b32 v28, v50 offset:2048
    ds_read_b32 v29, v50 offset:2304
    ds_read_b32 v30, v50 offset:2560
    ds_read_b32 v31, v50 offset:2816
    ds_read_b32 v32, v50 offset:3072
    ds_read_b32 v33, v50 offset:3328
    ds_read_b32 v34, v50 offset:3584
    ds_read_b32 v35, v50 offset:3840
    s_waitcnt lgkmcnt(0)
    v_add_f32 v20, v20, v28
    v_add_f32 v21, v21, v29
    v_add_f32 v22, v22, v30
    v_add_f32 v23, v23, v31
    v_add_f32 v24, v24, v32
    v_add_f32 v25, v25, v33
    v_add_f32 v26, v26, v34
    v_add_f32 v27, v27, v35
    v_add_f32 v20, v20, v24
    v_add_f32 v21, v21, v25
    v_add_f32 v22, v22, v26
    v_add_f32 v23, v23, v27
    v_add_f32 v20, v20, v22
    v_add_f32 v21, v21, v23
    v_add_f32 v48, v20, v21
    v_cvt_pk_bf16_f32 v48, v48, v48
    v_lshlrev_b32 v50, 1, v0
    ds_write_b16 v50, v48 offset:0
    s_waitcnt lgkmcnt(0)
    ds_read_b128 v[20:23], v14 offset:0
    s_lshl_b32 s3, s30, 7
    s_lshl_b32 s65, s30, 2
    s_add_u32 s80, s40, s65
    s_addc_u32 s81, s41, 0
    s_mov_b64 exec, 0xff
    s_waitcnt lgkmcnt(0)
    buffer_store_dwordx4 v[20:23], v14, s[40:43], s3 offen sc0 sc1
    s_mov_b64 exec, -1
    s_mov_b32 s64, 0
    s_mov_b32 s71, 1
    s_waitcnt vmcnt(0)
    v_mov_b32 v49, 0
    v_mov_b32 v51, 1
    s_mov_b64 exec, 1
    global_atomic_add v49, v51, s[80:81] offset:1024 sc1
    s_mov_b64 exec, -1
L_qpoll:
    s_load_dwordx4 s[76:79], s[40:41], 1024 glc
    s_waitcnt lgkmcnt(0)
    s_cmp_lg_u32 s64, 8
    s_cbranch_scc1 L_qp_nf
    v_mov_b32 v49, 0
    v_mov_b32 v51, 1
    s_mov_b64 exec, 1
    global_atomic_add v49, v51, s[84:85] offset:0 sc1
    s_mov_b64 exec, -1
L_qp_nf:
    s_cmp_eq_u32 s72, s76
    s_cbranch_scc1 L_qp_no
    s_cmp_eq_u32 s73, s77
    s_cbranch_scc1 L_qp_no
    s_cmp_eq_u32 s74, s78
    s_cbranch_scc1 L_qp_no
    s_cmp_eq_u32 s75, s79
    s_cbranch_scc1 L_qp_no
    s_branch L_qpoll_x
L_qp_no:
    s_add_u32 s64, s64, 1
    s_cmp_lt_u32 s64, 16
    s_cbranch_scc1 L_qpoll
    s_cmp_ge_u32 s64, 2097152
    s_cbranch_scc1 L_qpoll_x
    s_load_dword s70, s[84:85], 0 glc
    s_waitcnt lgkmcnt(0)
    s_and_b32 s70, s70, 0xff
    s_cmp_lt_u32 s70, 4
    s_cbranch_scc1 L_qpoll
L_qpoll_x:
    v_lshlrev_b32 v48, 3, v0
    buffer_load_dwordx2 v[20:21], v48, s[40:43], 0 offen sc0 sc1
    s_waitcnt vmcnt(0)
    ds_write_b64 v48, v[20:21] offset:23040
    s_waitcnt lgkmcnt(0)
L_q_done:
    s_barrier
    s_setprio 0
    s_cmp_eq_u32 s31, 0
    s_cbranch_scc1 L_ann0
    s_cmp_lt_u32 s31, 7
    s_cbranch_scc1 L_ann
    s_cmp_ge_u32 s15, 56
    s_cbranch_scc1 L_ann
    s_waitcnt vmcnt(0)
    v_mov_b32 v48, 25664
    v_mov_b32 v49, 1
    s_mov_b64 exec, 1
    ds_add_u32 v48, v49 offset:8
    s_mov_b64 exec, -1
    s_branch L_ann
L_ann0:
    s_cmp_ge_u32 s15, 56
    s_cbranch_scc1 L_ann1
    v_mov_b32 v48, 25664
HB_22:
    s_sleep 2
    ds_read_b32 v49, v48 offset:8
    s_waitcnt lgkmcnt(0)
    v_readfirstlane_b32 s3, v49
    s_cmp_lt_u32 s3, 6
    s_cbranch_scc1 HB_22
L_ann1:
    s_cmp_ge_u32 s64, 8
    s_cselect_b32 s3, 0, 1
    s_add_u32 s3, s3, 0x100
    v_mov_b32 v49, 0
    v_mov_b32 v51, s3
    s_mov_b64 exec, 1
    global_atomic_add v49, v51, s[84:85] offset:0 sc1
    s_mov_b64 exec, -1
L_ann:
    s_cmp_ge_u32 s15, 56
    s_cbranch_scc1 L_ffn_done
    s_bfe_u32 s60, s59, 0x30003
    s_and_b32 s61, s59, 7
    s_mul_i32 s63, s60, 7
    s_add_u32 s63, s63, s61
    s_cmp_lg_u32 s31, 7
    s_cbranch_scc1 L_ffn_done
L_f_h7:
    s_cmp_lg_u32 s30, s28
    s_cbranch_scc1 L_ffn_done
    s_lshr_b32 s64, s63, 1
    s_lshl_b32 s3, s64, 13
    s_and_b32 s64, s63, 1
    s_lshl_b32 s64, s64, 7
    s_add_u32 s3, s3, s64
    s_add_u32 s3, s3, 1572864
    s_add_u32 s36, s26, s3
    s_addc_u32 s37, s27, 0
    s_mov_b32 s38, 8064
    v_lshrrev_b32 v50, 7, v14
    v_lshlrev_b32 v50, 8, v50
    v_add_u32 v50, v50, v53
    s_mov_b32 s48, 0
    s_mov_b32 s49, 2048
    s_mov_b32 s50, 4096
    s_mov_b32 s51, 6144
    s_mov_b32 s52, 8192
    s_mov_b32 s53, 10240
    s_mov_b32 s54, 12288
    s_mov_b32 s55, 14336
    s_mul_i32 s3, s60, 200704
    s_lshl_b32 s64, s61, 7
    s_add_u32 s3, s3, s64
    s_add_u32 s32, s20, s3
    s_addc_u32 s33, s21, 0
    s_mov_b32 s34, 199936
    s_movk_i32 s3, 896
    v_mul_lo_u32 v13, v52, s3
    v_add_u32 v13, v13, v53
    s_mov_b32 s3, 0
    buffer_load_dwordx4 v[56:59], v13, s[32:35], s3 offen
    s_waitcnt vmcnt(3)
    s_mov_b32 s3, 7168
    buffer_load_dwordx4 v[60:63], v13, s[32:35], s3 offen
    s_waitcnt vmcnt(3)
    s_mov_b32 s3, 14336
    buffer_load_dwordx4 v[64:67], v13, s[32:35], s3 offen
    s_waitcnt vmcnt(3)
    s_mov_b32 s3, 21504
    buffer_load_dwordx4 v[68:71], v13, s[32:35], s3 offen
    s_waitcnt vmcnt(3)
    s_mov_b32 s3, 28672
    buffer_load_dwordx4 v[72:75], v13, s[32:35], s3 offen
    s_waitcnt vmcnt(3)
    s_mov_b32 s3, 35840
    buffer_load_dwordx4 v[76:79], v13, s[32:35], s3 offen
    s_waitcnt vmcnt(3)
    s_mov_b32 s3, 43008
    buffer_load_dwordx4 v[80:83], v13, s[32:35], s3 offen
    s_waitcnt vmcnt(3)
    s_mov_b32 s3, 50176
    buffer_load_dwordx4 v[84:87], v13, s[32:35], s3 offen
    s_waitcnt vmcnt(3)
    s_mov_b32 s64, s24
    s_mov_b32 s65, s25
    s_mov_b32 s66, 256
    v_lshrrev_b32 v48, 2, v14
    s_mov_b32 s67, 0x20000
    s_mov_b32 s68, 2097152
FW_23:
    buffer_load_dword v49, v48, s[64:67], 0 offen sc0 sc1
    s_sub_u32 s68, s68, 1
    s_waitcnt vmcnt(0)
    s_cmp_eq_u32 s68, 0
    s_cbranch_scc1 FW_23x
    v_cmp_gt_u32 vcc, 0x400, v49
    s_nop 3
    s_cbranch_vccz FW_23x
    s_sleep 32
    s_branch FW_23
FW_23x:
    buffer_load_dwordx4 v[20:23], v50, s[36:39], s48 offen sc0 sc1
    buffer_load_dwordx4 v[24:27], v50, s[36:39], s49 offen sc0 sc1
    buffer_load_dwordx4 v[28:31], v50, s[36:39], s50 offen sc0 sc1
    buffer_load_dwordx4 v[32:35], v50, s[36:39], s51 offen sc0 sc1
    s_lshl_b32 s3, s60, 14
    s_add_u32 s3, s3, 263936
    v_lshl_add_u32 v50, v2, 2, v3
    v_lshlrev_b32 v50, 2, v50
    s_waitcnt vmcnt(0)
    s_add_u32 s36, s26, s3
    s_addc_u32 s37, s27, 0
    s_mov_b32 s38, 409600
    v_add_f32 v20, v20, v28
    v_add_f32 v21, v21, v29
    v_add_f32 v22, v22, v30
    v_add_f32 v23, v23, v31
    v_add_f32 v24, v24, v32
    v_add_f32 v25, v25, v33
    v_add_f32 v26, v26, v34
    v_add_f32 v27, v27, v35
    v_add_f32 v20, v20, v24
    v_add_f32 v21, v21, v25
    v_add_f32 v22, v22, v26
    v_add_f32 v23, v23, v27
    v_cvt_pk_bf16_f32 v20, v20, v20
    v_and_b32 v20, 0xffff0000, v20
    v_cvt_pk_bf16_f32 v21, v21, v21
    v_and_b32 v21, 0xffff0000, v21
    v_cvt_pk_bf16_f32 v22, v22, v22
    v_and_b32 v22, 0xffff0000, v22
    v_cvt_pk_bf16_f32 v23, v23, v23
    v_and_b32 v23, 0xffff0000, v23
    ds_write_b128 v14, v[20:23] offset:8192
    s_waitcnt lgkmcnt(0)
    ds_read_b32 v8, v50 offset:8192
    ds_read_b32 v9, v50 offset:8448
    ds_read_b32 v10, v50 offset:8704
    ds_read_b32 v11, v50 offset:8960
    s_waitcnt lgkmcnt(0)
    v_mul_f32 v8, v8, v10
    v_mul_f32 v9, v9, v11
    v_cvt_pk_bf16_f32 v8, v8, v9
    v_min_u32 v8, -2, v8
    buffer_store_dword v8, v50, s[44:47], 0 offen offset:1792 sc0 sc1
    s_mov_b32 s3, 57344
    buffer_load_dwordx4 v[88:91], v13, s[32:35], s3 offen
    s_waitcnt vmcnt(3)
    s_mov_b32 s3, 64512
    buffer_load_dwordx4 v[92:95], v13, s[32:35], s3 offen
    s_waitcnt vmcnt(3)
    s_mov_b32 s3, 71680
    buffer_load_dwordx4 v[96:99], v13, s[32:35], s3 offen
    s_waitcnt vmcnt(3)
    s_mov_b32 s3, 78848
    buffer_load_dwordx4 v[100:103], v13, s[32:35], s3 offen
    s_waitcnt vmcnt(3)
    s_mov_b32 s3, 86016
    buffer_load_dwordx4 v[104:107], v13, s[32:35], s3 offen
    s_waitcnt vmcnt(3)
    s_mov_b32 s3, 93184
    buffer_load_dwordx4 v[108:111], v13, s[32:35], s3 offen
    s_waitcnt vmcnt(3)
    s_mov_b32 s3, 100352
    buffer_load_dwordx4 v[112:115], v13, s[32:35], s3 offen
    s_waitcnt vmcnt(3)
    s_mov_b32 s3, 107520
    buffer_load_dwordx4 v[116:119], v13, s[32:35], s3 offen
    s_waitcnt vmcnt(3)
    s_mov_b32 s3, 114688
    buffer_load_dwordx4 v[120:123], v13, s[32:35], s3 offen
    s_waitcnt vmcnt(3)
    s_mov_b32 s3, 121856
    buffer_load_dwordx4 v[124:127], v13, s[32:35], s3 offen
    s_waitcnt vmcnt(3)
    s_mov_b32 s3, 129024
    buffer_load_dwordx4 v[128:131], v13, s[32:35], s3 offen
    s_waitcnt vmcnt(3)
    s_mov_b32 s3, 136192
    buffer_load_dwordx4 v[132:135], v13, s[32:35], s3 offen
    s_waitcnt vmcnt(3)
    s_mov_b32 s3, 143360
    buffer_load_dwordx4 v[136:139], v13, s[32:35], s3 offen
    s_waitcnt vmcnt(3)
    s_mov_b32 s3, 150528
    buffer_load_dwordx4 v[140:143], v13, s[32:35], s3 offen
    s_waitcnt vmcnt(3)
    s_mov_b32 s3, 157696
    buffer_load_dwordx4 v[144:147], v13, s[32:35], s3 offen
    s_waitcnt vmcnt(3)
    s_mov_b32 s3, 164864
    buffer_load_dwordx4 v[148:151], v13, s[32:35], s3 offen
    s_waitcnt vmcnt(3)
    s_mov_b32 s3, 172032
    buffer_load_dwordx4 v[152:155], v13, s[32:35], s3 offen
    s_waitcnt vmcnt(3)
    s_mov_b32 s3, 179200
    buffer_load_dwordx4 v[156:159], v13, s[32:35], s3 offen
    s_waitcnt vmcnt(3)
    s_mov_b32 s3, 186368
    buffer_load_dwordx4 v[160:163], v13, s[32:35], s3 offen
    s_waitcnt vmcnt(3)
    s_mov_b32 s3, 193536
    buffer_load_dwordx4 v[164:167], v13, s[32:35], s3 offen
    s_waitcnt vmcnt(3)
    s_mov_b32 s48, 0
    s_mov_b32 s49, 133120
    s_mov_b32 s50, 266240
    s_mov_b32 s51, 399360
    s_mov_b32 s52, 8192
    s_mov_b32 s53, 141312
    s_mov_b32 s54, 274432
    s_mov_b32 s68, 2097152
SP_24:
    buffer_load_dword v36, v50, s[36:39], s48 offen sc0 sc1
    buffer_load_dword v37, v50, s[36:39], s49 offen sc0 sc1
    buffer_load_dword v38, v50, s[36:39], s50 offen sc0 sc1
    buffer_load_dword v39, v50, s[36:39], s51 offen sc0 sc1
    buffer_load_dword v40, v50, s[36:39], s52 offen sc0 sc1
    buffer_load_dword v41, v50, s[36:39], s53 offen sc0 sc1
    buffer_load_dword v42, v50, s[36:39], s54 offen sc0 sc1
    s_sub_u32 s68, s68, 1
    s_waitcnt vmcnt(0)
    s_cmp_eq_u32 s68, 0
    s_cbranch_scc1 SP_24x
    v_max_u32 v51, v36, v37
    v_max_u32 v51, v51, v38
    v_max_u32 v51, v51, v39
    v_max_u32 v51, v51, v40
    v_max_u32 v51, v51, v41
    v_max_u32 v51, v51, v42
    v_cmp_eq_u32 vcc, -1, v51
    s_nop 3
    s_cbranch_vccz SP_24x
    s_sleep 32
    s_branch SP_24
SP_24x:
    s_and_b32 s3, s59, 63
    s_lshl_b32 s3, s3, 10
    s_add_u32 s3, s3, 1048576
    s_add_u32 s36, s26, s3
    s_addc_u32 s37, s27, 0
    s_mov_b32 s38, 1024
    s_mov_b32 s64, 0x01000100
    s_mov_b32 s65, 0x03020302
    v_perm_b32 v8, v36, v36, s64
    v_perm_b32 v9, v36, v36, s65
    s_nop 1
    v_and_b32_dpp v16, v8, v4 row_newbcast:0 row_mask:0xf bank_mask:0x3
    v_and_b32_dpp v17, v8, v5 row_newbcast:0 row_mask:0xf bank_mask:0x3
    v_and_b32_dpp v18, v8, v6 row_newbcast:0 row_mask:0xf bank_mask:0x3
    v_and_b32_dpp v19, v8, v7 row_newbcast:0 row_mask:0xf bank_mask:0x3
    v_and_b32_dpp v16, v8, v4 row_newbcast:1 row_mask:0xf bank_mask:0xc
    v_and_b32_dpp v17, v8, v5 row_newbcast:1 row_mask:0xf bank_mask:0xc
    v_and_b32_dpp v18, v8, v6 row_newbcast:1 row_mask:0xf bank_mask:0xc
    v_and_b32_dpp v19, v8, v7 row_newbcast:1 row_mask:0xf bank_mask:0xc
    s_nop 1
    v_mfma_f32_16x16x32_bf16 v[20:23], v[16:19], v[56:59], 0
    v_and_b32_dpp v16, v8, v4 row_newbcast:8 row_mask:0xf bank_mask:0x3
    v_and_b32_dpp v17, v8, v5 row_newbcast:8 row_mask:0xf bank_mask:0x3
    v_and_b32_dpp v18, v8, v6 row_newbcast:8 row_mask:0xf bank_mask:0x3
    v_and_b32_dpp v19, v8, v7 row_newbcast:8 row_mask:0xf bank_mask:0x3
    v_and_b32_dpp v16, v8, v4 row_newbcast:9 row_mask:0xf bank_mask:0xc
    v_and_b32_dpp v17, v8, v5 row_newbcast:9 row_mask:0xf bank_mask:0xc
    v_and_b32_dpp v18, v8, v6 row_newbcast:9 row_mask:0xf bank_mask:0xc
    v_and_b32_dpp v19, v8, v7 row_newbcast:9 row_mask:0xf bank_mask:0xc
    s_nop 1
    v_mfma_f32_16x16x32_bf16 v[24:27], v[16:19], v[56:59], 0
    v_and_b32_dpp v16, v9, v4 row_newbcast:0 row_mask:0xf bank_mask:0x3
    v_and_b32_dpp v17, v9, v5 row_newbcast:0 row_mask:0xf bank_mask:0x3
    v_and_b32_dpp v18, v9, v6 row_newbcast:0 row_mask:0xf bank_mask:0x3
    v_and_b32_dpp v19, v9, v7 row_newbcast:0 row_mask:0xf bank_mask:0x3
    v_and_b32_dpp v16, v9, v4 row_newbcast:1 row_mask:0xf bank_mask:0xc
    v_and_b32_dpp v17, v9, v5 row_newbcast:1 row_mask:0xf bank_mask:0xc
    v_and_b32_dpp v18, v9, v6 row_newbcast:1 row_mask:0xf bank_mask:0xc
    v_and_b32_dpp v19, v9, v7 row_newbcast:1 row_mask:0xf bank_mask:0xc
    s_nop 1
    v_mfma_f32_16x16x32_bf16 v[28:31], v[16:19], v[56:59], 0
    v_and_b32_dpp v16, v9, v4 row_newbcast:8 row_mask:0xf bank_mask:0x3
    v_and_b32_dpp v17, v9, v5 row_newbcast:8 row_mask:0xf bank_mask:0x3
    v_and_b32_dpp v18, v9, v6 row_newbcast:8 row_mask:0xf bank_mask:0x3
    v_and_b32_dpp v19, v9, v7 row_newbcast:8 row_mask:0xf bank_mask:0x3
    v_and_b32_dpp v16, v9, v4 row_newbcast:9 row_mask:0xf bank_mask:0xc
    v_and_b32_dpp v17, v9, v5 row_newbcast:9 row_mask:0xf bank_mask:0xc
    v_and_b32_dpp v18, v9, v6 row_newbcast:9 row_mask:0xf bank_mask:0xc
    v_and_b32_dpp v19, v9, v7 row_newbcast:9 row_mask:0xf bank_mask:0xc
    s_nop 1
    v_mfma_f32_16x16x32_bf16 v[32:35], v[16:19], v[56:59], 0
    v_and_b32_dpp v16, v8, v4 row_newbcast:2 row_mask:0xf bank_mask:0x3
    v_and_b32_dpp v17, v8, v5 row_newbcast:2 row_mask:0xf bank_mask:0x3
    v_and_b32_dpp v18, v8, v6 row_newbcast:2 row_mask:0xf bank_mask:0x3
    v_and_b32_dpp v19, v8, v7 row_newbcast:2 row_mask:0xf bank_mask:0x3
    v_and_b32_dpp v16, v8, v4 row_newbcast:3 row_mask:0xf bank_mask:0xc
    v_and_b32_dpp v17, v8, v5 row_newbcast:3 row_mask:0xf bank_mask:0xc
    v_and_b32_dpp v18, v8, v6 row_newbcast:3 row_mask:0xf bank_mask:0xc
    v_and_b32_dpp v19, v8, v7 row_newbcast:3 row_mask:0xf bank_mask:0xc
    s_nop 1
    v_mfma_f32_16x16x32_bf16 v[20:23], v[16:19], v[60:63], v[20:23]
    v_and_b32_dpp v16, v8, v4 row_newbcast:10 row_mask:0xf bank_mask:0x3
    v_and_b32_dpp v17, v8, v5 row_newbcast:10 row_mask:0xf bank_mask:0x3
    v_and_b32_dpp v18, v8, v6 row_newbcast:10 row_mask:0xf bank_mask:0x3
    v_and_b32_dpp v19, v8, v7 row_newbcast:10 row_mask:0xf bank_mask:0x3
    v_and_b32_dpp v16, v8, v4 row_newbcast:11 row_mask:0xf bank_mask:0xc
    v_and_b32_dpp v17, v8, v5 row_newbcast:11 row_mask:0xf bank_mask:0xc
    v_and_b32_dpp v18, v8, v6 row_newbcast:11 row_mask:0xf bank_mask:0xc
    v_and_b32_dpp v19, v8, v7 row_newbcast:11 row_mask:0xf bank_mask:0xc
    s_nop 1
    v_mfma_f32_16x16x32_bf16 v[24:27], v[16:19], v[60:63], v[24:27]
    v_and_b32_dpp v16, v9, v4 row_newbcast:2 row_mask:0xf bank_mask:0x3
    v_and_b32_dpp v17, v9, v5 row_newbcast:2 row_mask:0xf bank_mask:0x3
    v_and_b32_dpp v18, v9, v6 row_newbcast:2 row_mask:0xf bank_mask:0x3
    v_and_b32_dpp v19, v9, v7 row_newbcast:2 row_mask:0xf bank_mask:0x3
    v_and_b32_dpp v16, v9, v4 row_newbcast:3 row_mask:0xf bank_mask:0xc
    v_and_b32_dpp v17, v9, v5 row_newbcast:3 row_mask:0xf bank_mask:0xc
    v_and_b32_dpp v18, v9, v6 row_newbcast:3 row_mask:0xf bank_mask:0xc
    v_and_b32_dpp v19, v9, v7 row_newbcast:3 row_mask:0xf bank_mask:0xc
    s_nop 1
    v_mfma_f32_16x16x32_bf16 v[28:31], v[16:19], v[60:63], v[28:31]
    v_and_b32_dpp v16, v9, v4 row_newbcast:10 row_mask:0xf bank_mask:0x3
    v_and_b32_dpp v17, v9, v5 row_newbcast:10 row_mask:0xf bank_mask:0x3
    v_and_b32_dpp v18, v9, v6 row_newbcast:10 row_mask:0xf bank_mask:0x3
    v_and_b32_dpp v19, v9, v7 row_newbcast:10 row_mask:0xf bank_mask:0x3
    v_and_b32_dpp v16, v9, v4 row_newbcast:11 row_mask:0xf bank_mask:0xc
    v_and_b32_dpp v17, v9, v5 row_newbcast:11 row_mask:0xf bank_mask:0xc
    v_and_b32_dpp v18, v9, v6 row_newbcast:11 row_mask:0xf bank_mask:0xc
    v_and_b32_dpp v19, v9, v7 row_newbcast:11 row_mask:0xf bank_mask:0xc
    s_nop 1
    v_mfma_f32_16x16x32_bf16 v[32:35], v[16:19], v[60:63], v[32:35]
    v_and_b32_dpp v16, v8, v4 row_newbcast:4 row_mask:0xf bank_mask:0x3
    v_and_b32_dpp v17, v8, v5 row_newbcast:4 row_mask:0xf bank_mask:0x3
    v_and_b32_dpp v18, v8, v6 row_newbcast:4 row_mask:0xf bank_mask:0x3
    v_and_b32_dpp v19, v8, v7 row_newbcast:4 row_mask:0xf bank_mask:0x3
    v_and_b32_dpp v16, v8, v4 row_newbcast:5 row_mask:0xf bank_mask:0xc
    v_and_b32_dpp v17, v8, v5 row_newbcast:5 row_mask:0xf bank_mask:0xc
    v_and_b32_dpp v18, v8, v6 row_newbcast:5 row_mask:0xf bank_mask:0xc
    v_and_b32_dpp v19, v8, v7 row_newbcast:5 row_mask:0xf bank_mask:0xc
    s_nop 1
    v_mfma_f32_16x16x32_bf16 v[20:23], v[16:19], v[64:67], v[20:23]
    v_and_b32_dpp v16, v8, v4 row_newbcast:12 row_mask:0xf bank_mask:0x3
    v_and_b32_dpp v17, v8, v5 row_newbcast:12 row_mask:0xf bank_mask:0x3
    v_and_b32_dpp v18, v8, v6 row_newbcast:12 row_mask:0xf bank_mask:0x3
    v_and_b32_dpp v19, v8, v7 row_newbcast:12 row_mask:0xf bank_mask:0x3
    v_and_b32_dpp v16, v8, v4 row_newbcast:13 row_mask:0xf bank_mask:0xc
    v_and_b32_dpp v17, v8, v5 row_newbcast:13 row_mask:0xf bank_mask:0xc
    v_and_b32_dpp v18, v8, v6 row_newbcast:13 row_mask:0xf bank_mask:0xc
    v_and_b32_dpp v19, v8, v7 row_newbcast:13 row_mask:0xf bank_mask:0xc
    s_nop 1
    v_mfma_f32_16x16x32_bf16 v[24:27], v[16:19], v[64:67], v[24:27]
    v_and_b32_dpp v16, v9, v4 row_newbcast:4 row_mask:0xf bank_mask:0x3
    v_and_b32_dpp v17, v9, v5 row_newbcast:4 row_mask:0xf bank_mask:0x3
    v_and_b32_dpp v18, v9, v6 row_newbcast:4 row_mask:0xf bank_mask:0x3
    v_and_b32_dpp v19, v9, v7 row_newbcast:4 row_mask:0xf bank_mask:0x3
    v_and_b32_dpp v16, v9, v4 row_newbcast:5 row_mask:0xf bank_mask:0xc
    v_and_b32_dpp v17, v9, v5 row_newbcast:5 row_mask:0xf bank_mask:0xc
    v_and_b32_dpp v18, v9, v6 row_newbcast:5 row_mask:0xf bank_mask:0xc
    v_and_b32_dpp v19, v9, v7 row_newbcast:5 row_mask:0xf bank_mask:0xc
    s_nop 1
    v_mfma_f32_16x16x32_bf16 v[28:31], v[16:19], v[64:67], v[28:31]
    v_and_b32_dpp v16, v9, v4 row_newbcast:12 row_mask:0xf bank_mask:0x3
    v_and_b32_dpp v17, v9, v5 row_newbcast:12 row_mask:0xf bank_mask:0x3
    v_and_b32_dpp v18, v9, v6 row_newbcast:12 row_mask:0xf bank_mask:0x3
    v_and_b32_dpp v19, v9, v7 row_newbcast:12 row_mask:0xf bank_mask:0x3
    v_and_b32_dpp v16, v9, v4 row_newbcast:13 row_mask:0xf bank_mask:0xc
    v_and_b32_dpp v17, v9, v5 row_newbcast:13 row_mask:0xf bank_mask:0xc
    v_and_b32_dpp v18, v9, v6 row_newbcast:13 row_mask:0xf bank_mask:0xc
    v_and_b32_dpp v19, v9, v7 row_newbcast:13 row_mask:0xf bank_mask:0xc
    s_nop 1
    v_mfma_f32_16x16x32_bf16 v[32:35], v[16:19], v[64:67], v[32:35]
    v_and_b32_dpp v16, v8, v4 row_newbcast:6 row_mask:0xf bank_mask:0x3
    v_and_b32_dpp v17, v8, v5 row_newbcast:6 row_mask:0xf bank_mask:0x3
    v_and_b32_dpp v18, v8, v6 row_newbcast:6 row_mask:0xf bank_mask:0x3
    v_and_b32_dpp v19, v8, v7 row_newbcast:6 row_mask:0xf bank_mask:0x3
    v_and_b32_dpp v16, v8, v4 row_newbcast:7 row_mask:0xf bank_mask:0xc
    v_and_b32_dpp v17, v8, v5 row_newbcast:7 row_mask:0xf bank_mask:0xc
    v_and_b32_dpp v18, v8, v6 row_newbcast:7 row_mask:0xf bank_mask:0xc
    v_and_b32_dpp v19, v8, v7 row_newbcast:7 row_mask:0xf bank_mask:0xc
    s_nop 1
    v_mfma_f32_16x16x32_bf16 v[20:23], v[16:19], v[68:71], v[20:23]
    v_and_b32_dpp v16, v8, v4 row_newbcast:14 row_mask:0xf bank_mask:0x3
    v_and_b32_dpp v17, v8, v5 row_newbcast:14 row_mask:0xf bank_mask:0x3
    v_and_b32_dpp v18, v8, v6 row_newbcast:14 row_mask:0xf bank_mask:0x3
    v_and_b32_dpp v19, v8, v7 row_newbcast:14 row_mask:0xf bank_mask:0x3
    v_and_b32_dpp v16, v8, v4 row_newbcast:15 row_mask:0xf bank_mask:0xc
    v_and_b32_dpp v17, v8, v5 row_newbcast:15 row_mask:0xf bank_mask:0xc
    v_and_b32_dpp v18, v8, v6 row_newbcast:15 row_mask:0xf bank_mask:0xc
    v_and_b32_dpp v19, v8, v7 row_newbcast:15 row_mask:0xf bank_mask:0xc
    s_nop 1
    v_mfma_f32_16x16x32_bf16 v[24:27], v[16:19], v[68:71], v[24:27]
    v_and_b32_dpp v16, v9, v4 row_newbcast:6 row_mask:0xf bank_mask:0x3
    v_and_b32_dpp v17, v9, v5 row_newbcast:6 row_mask:0xf bank_mask:0x3
    v_and_b32_dpp v18, v9, v6 row_newbcast:6 row_mask:0xf bank_mask:0x3
    v_and_b32_dpp v19, v9, v7 row_newbcast:6 row_mask:0xf bank_mask:0x3
    v_and_b32_dpp v16, v9, v4 row_newbcast:7 row_mask:0xf bank_mask:0xc
    v_and_b32_dpp v17, v9, v5 row_newbcast:7 row_mask:0xf bank_mask:0xc
    v_and_b32_dpp v18, v9, v6 row_newbcast:7 row_mask:0xf bank_mask:0xc
    v_and_b32_dpp v19, v9, v7 row_newbcast:7 row_mask:0xf bank_mask:0xc
    s_nop 1
    v_mfma_f32_16x16x32_bf16 v[28:31], v[16:19], v[68:71], v[28:31]
    v_and_b32_dpp v16, v9, v4 row_newbcast:14 row_mask:0xf bank_mask:0x3
    v_and_b32_dpp v17, v9, v5 row_newbcast:14 row_mask:0xf bank_mask:0x3
    v_and_b32_dpp v18, v9, v6 row_newbcast:14 row_mask:0xf bank_mask:0x3
    v_and_b32_dpp v19, v9, v7 row_newbcast:14 row_mask:0xf bank_mask:0x3
    v_and_b32_dpp v16, v9, v4 row_newbcast:15 row_mask:0xf bank_mask:0xc
    v_and_b32_dpp v17, v9, v5 row_newbcast:15 row_mask:0xf bank_mask:0xc
    v_and_b32_dpp v18, v9, v6 row_newbcast:15 row_mask:0xf bank_mask:0xc
    v_and_b32_dpp v19, v9, v7 row_newbcast:15 row_mask:0xf bank_mask:0xc
    s_nop 1
    v_mfma_f32_16x16x32_bf16 v[32:35], v[16:19], v[68:71], v[32:35]
    v_perm_b32 v8, v37, v37, s64
    v_perm_b32 v9, v37, v37, s65
    s_nop 1
    v_and_b32_dpp v16, v8, v4 row_newbcast:0 row_mask:0xf bank_mask:0x3
    v_and_b32_dpp v17, v8, v5 row_newbcast:0 row_mask:0xf bank_mask:0x3
    v_and_b32_dpp v18, v8, v6 row_newbcast:0 row_mask:0xf bank_mask:0x3
    v_and_b32_dpp v19, v8, v7 row_newbcast:0 row_mask:0xf bank_mask:0x3
    v_and_b32_dpp v16, v8, v4 row_newbcast:1 row_mask:0xf bank_mask:0xc
    v_and_b32_dpp v17, v8, v5 row_newbcast:1 row_mask:0xf bank_mask:0xc
    v_and_b32_dpp v18, v8, v6 row_newbcast:1 row_mask:0xf bank_mask:0xc
    v_and_b32_dpp v19, v8, v7 row_newbcast:1 row_mask:0xf bank_mask:0xc
    s_nop 1
    v_mfma_f32_16x16x32_bf16 v[20:23], v[16:19], v[72:75], v[20:23]
    v_and_b32_dpp v16, v8, v4 row_newbcast:8 row_mask:0xf bank_mask:0x3
    v_and_b32_dpp v17, v8, v5 row_newbcast:8 row_mask:0xf bank_mask:0x3
    v_and_b32_dpp v18, v8, v6 row_newbcast:8 row_mask:0xf bank_mask:0x3
    v_and_b32_dpp v19, v8, v7 row_newbcast:8 row_mask:0xf bank_mask:0x3
    v_and_b32_dpp v16, v8, v4 row_newbcast:9 row_mask:0xf bank_mask:0xc
    v_and_b32_dpp v17, v8, v5 row_newbcast:9 row_mask:0xf bank_mask:0xc
    v_and_b32_dpp v18, v8, v6 row_newbcast:9 row_mask:0xf bank_mask:0xc
    v_and_b32_dpp v19, v8, v7 row_newbcast:9 row_mask:0xf bank_mask:0xc
    s_nop 1
    v_mfma_f32_16x16x32_bf16 v[24:27], v[16:19], v[72:75], v[24:27]
    v_and_b32_dpp v16, v9, v4 row_newbcast:0 row_mask:0xf bank_mask:0x3
    v_and_b32_dpp v17, v9, v5 row_newbcast:0 row_mask:0xf bank_mask:0x3
    v_and_b32_dpp v18, v9, v6 row_newbcast:0 row_mask:0xf bank_mask:0x3
    v_and_b32_dpp v19, v9, v7 row_newbcast:0 row_mask:0xf bank_mask:0x3
    v_and_b32_dpp v16, v9, v4 row_newbcast:1 row_mask:0xf bank_mask:0xc
    v_and_b32_dpp v17, v9, v5 row_newbcast:1 row_mask:0xf bank_mask:0xc
    v_and_b32_dpp v18, v9, v6 row_newbcast:1 row_mask:0xf bank_mask:0xc
    v_and_b32_dpp v19, v9, v7 row_newbcast:1 row_mask:0xf bank_mask:0xc
    s_nop 1
    v_mfma_f32_16x16x32_bf16 v[28:31], v[16:19], v[72:75], v[28:31]
    v_and_b32_dpp v16, v9, v4 row_newbcast:8 row_mask:0xf bank_mask:0x3
    v_and_b32_dpp v17, v9, v5 row_newbcast:8 row_mask:0xf bank_mask:0x3
    v_and_b32_dpp v18, v9, v6 row_newbcast:8 row_mask:0xf bank_mask:0x3
    v_and_b32_dpp v19, v9, v7 row_newbcast:8 row_mask:0xf bank_mask:0x3
    v_and_b32_dpp v16, v9, v4 row_newbcast:9 row_mask:0xf bank_mask:0xc
    v_and_b32_dpp v17, v9, v5 row_newbcast:9 row_mask:0xf bank_mask:0xc
    v_and_b32_dpp v18, v9, v6 row_newbcast:9 row_mask:0xf bank_mask:0xc
    v_and_b32_dpp v19, v9, v7 row_newbcast:9 row_mask:0xf bank_mask:0xc
    s_nop 1
    v_mfma_f32_16x16x32_bf16 v[32:35], v[16:19], v[72:75], v[32:35]
    v_and_b32_dpp v16, v8, v4 row_newbcast:2 row_mask:0xf bank_mask:0x3
    v_and_b32_dpp v17, v8, v5 row_newbcast:2 row_mask:0xf bank_mask:0x3
    v_and_b32_dpp v18, v8, v6 row_newbcast:2 row_mask:0xf bank_mask:0x3
    v_and_b32_dpp v19, v8, v7 row_newbcast:2 row_mask:0xf bank_mask:0x3
    v_and_b32_dpp v16, v8, v4 row_newbcast:3 row_mask:0xf bank_mask:0xc
    v_and_b32_dpp v17, v8, v5 row_newbcast:3 row_mask:0xf bank_mask:0xc
    v_and_b32_dpp v18, v8, v6 row_newbcast:3 row_mask:0xf bank_mask:0xc
    v_and_b32_dpp v19, v8, v7 row_newbcast:3 row_mask:0xf bank_mask:0xc
    s_nop 1
    v_mfma_f32_16x16x32_bf16 v[20:23], v[16:19], v[76:79], v[20:23]
    v_and_b32_dpp v16, v8, v4 row_newbcast:10 row_mask:0xf bank_mask:0x3
    v_and_b32_dpp v17, v8, v5 row_newbcast:10 row_mask:0xf bank_mask:0x3
    v_and_b32_dpp v18, v8, v6 row_newbcast:10 row_mask:0xf bank_mask:0x3
    v_and_b32_dpp v19, v8, v7 row_newbcast:10 row_mask:0xf bank_mask:0x3
    v_and_b32_dpp v16, v8, v4 row_newbcast:11 row_mask:0xf bank_mask:0xc
    v_and_b32_dpp v17, v8, v5 row_newbcast:11 row_mask:0xf bank_mask:0xc
    v_and_b32_dpp v18, v8, v6 row_newbcast:11 row_mask:0xf bank_mask:0xc
    v_and_b32_dpp v19, v8, v7 row_newbcast:11 row_mask:0xf bank_mask:0xc
    s_nop 1
    v_mfma_f32_16x16x32_bf16 v[24:27], v[16:19], v[76:79], v[24:27]
    v_and_b32_dpp v16, v9, v4 row_newbcast:2 row_mask:0xf bank_mask:0x3
    v_and_b32_dpp v17, v9, v5 row_newbcast:2 row_mask:0xf bank_mask:0x3
    v_and_b32_dpp v18, v9, v6 row_newbcast:2 row_mask:0xf bank_mask:0x3
    v_and_b32_dpp v19, v9, v7 row_newbcast:2 row_mask:0xf bank_mask:0x3
    v_and_b32_dpp v16, v9, v4 row_newbcast:3 row_mask:0xf bank_mask:0xc
    v_and_b32_dpp v17, v9, v5 row_newbcast:3 row_mask:0xf bank_mask:0xc
    v_and_b32_dpp v18, v9, v6 row_newbcast:3 row_mask:0xf bank_mask:0xc
    v_and_b32_dpp v19, v9, v7 row_newbcast:3 row_mask:0xf bank_mask:0xc
    s_nop 1
    v_mfma_f32_16x16x32_bf16 v[28:31], v[16:19], v[76:79], v[28:31]
    v_and_b32_dpp v16, v9, v4 row_newbcast:10 row_mask:0xf bank_mask:0x3
    v_and_b32_dpp v17, v9, v5 row_newbcast:10 row_mask:0xf bank_mask:0x3
    v_and_b32_dpp v18, v9, v6 row_newbcast:10 row_mask:0xf bank_mask:0x3
    v_and_b32_dpp v19, v9, v7 row_newbcast:10 row_mask:0xf bank_mask:0x3
    v_and_b32_dpp v16, v9, v4 row_newbcast:11 row_mask:0xf bank_mask:0xc
    v_and_b32_dpp v17, v9, v5 row_newbcast:11 row_mask:0xf bank_mask:0xc
    v_and_b32_dpp v18, v9, v6 row_newbcast:11 row_mask:0xf bank_mask:0xc
    v_and_b32_dpp v19, v9, v7 row_newbcast:11 row_mask:0xf bank_mask:0xc
    s_nop 1
    v_mfma_f32_16x16x32_bf16 v[32:35], v[16:19], v[76:79], v[32:35]
    v_and_b32_dpp v16, v8, v4 row_newbcast:4 row_mask:0xf bank_mask:0x3
    v_and_b32_dpp v17, v8, v5 row_newbcast:4 row_mask:0xf bank_mask:0x3
    v_and_b32_dpp v18, v8, v6 row_newbcast:4 row_mask:0xf bank_mask:0x3
    v_and_b32_dpp v19, v8, v7 row_newbcast:4 row_mask:0xf bank_mask:0x3
    v_and_b32_dpp v16, v8, v4 row_newbcast:5 row_mask:0xf bank_mask:0xc
    v_and_b32_dpp v17, v8, v5 row_newbcast:5 row_mask:0xf bank_mask:0xc
    v_and_b32_dpp v18, v8, v6 row_newbcast:5 row_mask:0xf bank_mask:0xc
    v_and_b32_dpp v19, v8, v7 row_newbcast:5 row_mask:0xf bank_mask:0xc
    s_nop 1
    v_mfma_f32_16x16x32_bf16 v[20:23], v[16:19], v[80:83], v[20:23]
    v_and_b32_dpp v16, v8, v4 row_newbcast:12 row_mask:0xf bank_mask:0x3
    v_and_b32_dpp v17, v8, v5 row_newbcast:12 row_mask:0xf bank_mask:0x3
    v_and_b32_dpp v18, v8, v6 row_newbcast:12 row_mask:0xf bank_mask:0x3
    v_and_b32_dpp v19, v8, v7 row_newbcast:12 row_mask:0xf bank_mask:0x3
    v_and_b32_dpp v16, v8, v4 row_newbcast:13 row_mask:0xf bank_mask:0xc
    v_and_b32_dpp v17, v8, v5 row_newbcast:13 row_mask:0xf bank_mask:0xc
    v_and_b32_dpp v18, v8, v6 row_newbcast:13 row_mask:0xf bank_mask:0xc
    v_and_b32_dpp v19, v8, v7 row_newbcast:13 row_mask:0xf bank_mask:0xc
    s_nop 1
    v_mfma_f32_16x16x32_bf16 v[24:27], v[16:19], v[80:83], v[24:27]
    v_and_b32_dpp v16, v9, v4 row_newbcast:4 row_mask:0xf bank_mask:0x3
    v_and_b32_dpp v17, v9, v5 row_newbcast:4 row_mask:0xf bank_mask:0x3
    v_and_b32_dpp v18, v9, v6 row_newbcast:4 row_mask:0xf bank_mask:0x3
    v_and_b32_dpp v19, v9, v7 row_newbcast:4 row_mask:0xf bank_mask:0x3
    v_and_b32_dpp v16, v9, v4 row_newbcast:5 row_mask:0xf bank_mask:0xc
    v_and_b32_dpp v17, v9, v5 row_newbcast:5 row_mask:0xf bank_mask:0xc
    v_and_b32_dpp v18, v9, v6 row_newbcast:5 row_mask:0xf bank_mask:0xc
    v_and_b32_dpp v19, v9, v7 row_newbcast:5 row_mask:0xf bank_mask:0xc
    s_nop 1
    v_mfma_f32_16x16x32_bf16 v[28:31], v[16:19], v[80:83], v[28:31]
    v_and_b32_dpp v16, v9, v4 row_newbcast:12 row_mask:0xf bank_mask:0x3
    v_and_b32_dpp v17, v9, v5 row_newbcast:12 row_mask:0xf bank_mask:0x3
    v_and_b32_dpp v18, v9, v6 row_newbcast:12 row_mask:0xf bank_mask:0x3
    v_and_b32_dpp v19, v9, v7 row_newbcast:12 row_mask:0xf bank_mask:0x3
    v_and_b32_dpp v16, v9, v4 row_newbcast:13 row_mask:0xf bank_mask:0xc
    v_and_b32_dpp v17, v9, v5 row_newbcast:13 row_mask:0xf bank_mask:0xc
    v_and_b32_dpp v18, v9, v6 row_newbcast:13 row_mask:0xf bank_mask:0xc
    v_and_b32_dpp v19, v9, v7 row_newbcast:13 row_mask:0xf bank_mask:0xc
    s_nop 1
    v_mfma_f32_16x16x32_bf16 v[32:35], v[16:19], v[80:83], v[32:35]
    v_and_b32_dpp v16, v8, v4 row_newbcast:6 row_mask:0xf bank_mask:0x3
    v_and_b32_dpp v17, v8, v5 row_newbcast:6 row_mask:0xf bank_mask:0x3
    v_and_b32_dpp v18, v8, v6 row_newbcast:6 row_mask:0xf bank_mask:0x3
    v_and_b32_dpp v19, v8, v7 row_newbcast:6 row_mask:0xf bank_mask:0x3
    v_and_b32_dpp v16, v8, v4 row_newbcast:7 row_mask:0xf bank_mask:0xc
    v_and_b32_dpp v17, v8, v5 row_newbcast:7 row_mask:0xf bank_mask:0xc
    v_and_b32_dpp v18, v8, v6 row_newbcast:7 row_mask:0xf bank_mask:0xc
    v_and_b32_dpp v19, v8, v7 row_newbcast:7 row_mask:0xf bank_mask:0xc
    s_nop 1
    v_mfma_f32_16x16x32_bf16 v[20:23], v[16:19], v[84:87], v[20:23]
    v_and_b32_dpp v16, v8, v4 row_newbcast:14 row_mask:0xf bank_mask:0x3
    v_and_b32_dpp v17, v8, v5 row_newbcast:14 row_mask:0xf bank_mask:0x3
    v_and_b32_dpp v18, v8, v6 row_newbcast:14 row_mask:0xf bank_mask:0x3
    v_and_b32_dpp v19, v8, v7 row_newbcast:14 row_mask:0xf bank_mask:0x3
    v_and_b32_dpp v16, v8, v4 row_newbcast:15 row_mask:0xf bank_mask:0xc
    v_and_b32_dpp v17, v8, v5 row_newbcast:15 row_mask:0xf bank_mask:0xc
    v_and_b32_dpp v18, v8, v6 row_newbcast:15 row_mask:0xf bank_mask:0xc
    v_and_b32_dpp v19, v8, v7 row_newbcast:15 row_mask:0xf bank_mask:0xc
    s_nop 1
    v_mfma_f32_16x16x32_bf16 v[24:27], v[16:19], v[84:87], v[24:27]
    v_and_b32_dpp v16, v9, v4 row_newbcast:6 row_mask:0xf bank_mask:0x3
    v_and_b32_dpp v17, v9, v5 row_newbcast:6 row_mask:0xf bank_mask:0x3
    v_and_b32_dpp v18, v9, v6 row_newbcast:6 row_mask:0xf bank_mask:0x3
    v_and_b32_dpp v19, v9, v7 row_newbcast:6 row_mask:0xf bank_mask:0x3
    v_and_b32_dpp v16, v9, v4 row_newbcast:7 row_mask:0xf bank_mask:0xc
    v_and_b32_dpp v17, v9, v5 row_newbcast:7 row_mask:0xf bank_mask:0xc
    v_and_b32_dpp v18, v9, v6 row_newbcast:7 row_mask:0xf bank_mask:0xc
    v_and_b32_dpp v19, v9, v7 row_newbcast:7 row_mask:0xf bank_mask:0xc
    s_nop 1
    v_mfma_f32_16x16x32_bf16 v[28:31], v[16:19], v[84:87], v[28:31]
    v_and_b32_dpp v16, v9, v4 row_newbcast:14 row_mask:0xf bank_mask:0x3
    v_and_b32_dpp v17, v9, v5 row_newbcast:14 row_mask:0xf bank_mask:0x3
    v_and_b32_dpp v18, v9, v6 row_newbcast:14 row_mask:0xf bank_mask:0x3
    v_and_b32_dpp v19, v9, v7 row_newbcast:14 row_mask:0xf bank_mask:0x3
    v_and_b32_dpp v16, v9, v4 row_newbcast:15 row_mask:0xf bank_mask:0xc
    v_and_b32_dpp v17, v9, v5 row_newbcast:15 row_mask:0xf bank_mask:0xc
    v_and_b32_dpp v18, v9, v6 row_newbcast:15 row_mask:0xf bank_mask:0xc
    v_and_b32_dpp v19, v9, v7 row_newbcast:15 row_mask:0xf bank_mask:0xc
    s_nop 1
    v_mfma_f32_16x16x32_bf16 v[32:35], v[16:19], v[84:87], v[32:35]
    v_perm_b32 v8, v38, v38, s64
    v_perm_b32 v9, v38, v38, s65
    s_nop 1
    v_and_b32_dpp v16, v8, v4 row_newbcast:0 row_mask:0xf bank_mask:0x3
    v_and_b32_dpp v17, v8, v5 row_newbcast:0 row_mask:0xf bank_mask:0x3
    v_and_b32_dpp v18, v8, v6 row_newbcast:0 row_mask:0xf bank_mask:0x3
    v_and_b32_dpp v19, v8, v7 row_newbcast:0 row_mask:0xf bank_mask:0x3
    v_and_b32_dpp v16, v8, v4 row_newbcast:1 row_mask:0xf bank_mask:0xc
    v_and_b32_dpp v17, v8, v5 row_newbcast:1 row_mask:0xf bank_mask:0xc
    v_and_b32_dpp v18, v8, v6 row_newbcast:1 row_mask:0xf bank_mask:0xc
    v_and_b32_dpp v19, v8, v7 row_newbcast:1 row_mask:0xf bank_mask:0xc
    s_nop 1
    v_mfma_f32_16x16x32_bf16 v[20:23], v[16:19], v[88:91], v[20:23]
    v_and_b32_dpp v16, v8, v4 row_newbcast:8 row_mask:0xf bank_mask:0x3
    v_and_b32_dpp v17, v8, v5 row_newbcast:8 row_mask:0xf bank_mask:0x3
    v_and_b32_dpp v18, v8, v6 row_newbcast:8 row_mask:0xf bank_mask:0x3
    v_and_b32_dpp v19, v8, v7 row_newbcast:8 row_mask:0xf bank_mask:0x3
    v_and_b32_dpp v16, v8, v4 row_newbcast:9 row_mask:0xf bank_mask:0xc
    v_and_b32_dpp v17, v8, v5 row_newbcast:9 row_mask:0xf bank_mask:0xc
    v_and_b32_dpp v18, v8, v6 row_newbcast:9 row_mask:0xf bank_mask:0xc
    v_and_b32_dpp v19, v8, v7 row_newbcast:9 row_mask:0xf bank_mask:0xc
    s_nop 1
    v_mfma_f32_16x16x32_bf16 v[24:27], v[16:19], v[88:91], v[24:27]
    v_and_b32_dpp v16, v9, v4 row_newbcast:0 row_mask:0xf bank_mask:0x3
    v_and_b32_dpp v17, v9, v5 row_newbcast:0 row_mask:0xf bank_mask:0x3
    v_and_b32_dpp v18, v9, v6 row_newbcast:0 row_mask:0xf bank_mask:0x3
    v_and_b32_dpp v19, v9, v7 row_newbcast:0 row_mask:0xf bank_mask:0x3
    v_and_b32_dpp v16, v9, v4 row_newbcast:1 row_mask:0xf bank_mask:0xc
    v_and_b32_dpp v17, v9, v5 row_newbcast:1 row_mask:0xf bank_mask:0xc
    v_and_b32_dpp v18, v9, v6 row_newbcast:1 row_mask:0xf bank_mask:0xc
    v_and_b32_dpp v19, v9, v7 row_newbcast:1 row_mask:0xf bank_mask:0xc
    s_nop 1
    v_mfma_f32_16x16x32_bf16 v[28:31], v[16:19], v[88:91], v[28:31]
    v_and_b32_dpp v16, v9, v4 row_newbcast:8 row_mask:0xf bank_mask:0x3
    v_and_b32_dpp v17, v9, v5 row_newbcast:8 row_mask:0xf bank_mask:0x3
    v_and_b32_dpp v18, v9, v6 row_newbcast:8 row_mask:0xf bank_mask:0x3
    v_and_b32_dpp v19, v9, v7 row_newbcast:8 row_mask:0xf bank_mask:0x3
    v_and_b32_dpp v16, v9, v4 row_newbcast:9 row_mask:0xf bank_mask:0xc
    v_and_b32_dpp v17, v9, v5 row_newbcast:9 row_mask:0xf bank_mask:0xc
    v_and_b32_dpp v18, v9, v6 row_newbcast:9 row_mask:0xf bank_mask:0xc
    v_and_b32_dpp v19, v9, v7 row_newbcast:9 row_mask:0xf bank_mask:0xc
    s_nop 1
    v_mfma_f32_16x16x32_bf16 v[32:35], v[16:19], v[88:91], v[32:35]
    v_and_b32_dpp v16, v8, v4 row_newbcast:2 row_mask:0xf bank_mask:0x3
    v_and_b32_dpp v17, v8, v5 row_newbcast:2 row_mask:0xf bank_mask:0x3
    v_and_b32_dpp v18, v8, v6 row_newbcast:2 row_mask:0xf bank_mask:0x3
    v_and_b32_dpp v19, v8, v7 row_newbcast:2 row_mask:0xf bank_mask:0x3
    v_and_b32_dpp v16, v8, v4 row_newbcast:3 row_mask:0xf bank_mask:0xc
    v_and_b32_dpp v17, v8, v5 row_newbcast:3 row_mask:0xf bank_mask:0xc
    v_and_b32_dpp v18, v8, v6 row_newbcast:3 row_mask:0xf bank_mask:0xc
    v_and_b32_dpp v19, v8, v7 row_newbcast:3 row_mask:0xf bank_mask:0xc
    s_nop 1
    v_mfma_f32_16x16x32_bf16 v[20:23], v[16:19], v[92:95], v[20:23]
    v_and_b32_dpp v16, v8, v4 row_newbcast:10 row_mask:0xf bank_mask:0x3
    v_and_b32_dpp v17, v8, v5 row_newbcast:10 row_mask:0xf bank_mask:0x3
    v_and_b32_dpp v18, v8, v6 row_newbcast:10 row_mask:0xf bank_mask:0x3
    v_and_b32_dpp v19, v8, v7 row_newbcast:10 row_mask:0xf bank_mask:0x3
    v_and_b32_dpp v16, v8, v4 row_newbcast:11 row_mask:0xf bank_mask:0xc
    v_and_b32_dpp v17, v8, v5 row_newbcast:11 row_mask:0xf bank_mask:0xc
    v_and_b32_dpp v18, v8, v6 row_newbcast:11 row_mask:0xf bank_mask:0xc
    v_and_b32_dpp v19, v8, v7 row_newbcast:11 row_mask:0xf bank_mask:0xc
    s_nop 1
    v_mfma_f32_16x16x32_bf16 v[24:27], v[16:19], v[92:95], v[24:27]
    v_and_b32_dpp v16, v9, v4 row_newbcast:2 row_mask:0xf bank_mask:0x3
    v_and_b32_dpp v17, v9, v5 row_newbcast:2 row_mask:0xf bank_mask:0x3
    v_and_b32_dpp v18, v9, v6 row_newbcast:2 row_mask:0xf bank_mask:0x3
    v_and_b32_dpp v19, v9, v7 row_newbcast:2 row_mask:0xf bank_mask:0x3
    v_and_b32_dpp v16, v9, v4 row_newbcast:3 row_mask:0xf bank_mask:0xc
    v_and_b32_dpp v17, v9, v5 row_newbcast:3 row_mask:0xf bank_mask:0xc
    v_and_b32_dpp v18, v9, v6 row_newbcast:3 row_mask:0xf bank_mask:0xc
    v_and_b32_dpp v19, v9, v7 row_newbcast:3 row_mask:0xf bank_mask:0xc
    s_nop 1
    v_mfma_f32_16x16x32_bf16 v[28:31], v[16:19], v[92:95], v[28:31]
    v_and_b32_dpp v16, v9, v4 row_newbcast:10 row_mask:0xf bank_mask:0x3
    v_and_b32_dpp v17, v9, v5 row_newbcast:10 row_mask:0xf bank_mask:0x3
    v_and_b32_dpp v18, v9, v6 row_newbcast:10 row_mask:0xf bank_mask:0x3
    v_and_b32_dpp v19, v9, v7 row_newbcast:10 row_mask:0xf bank_mask:0x3
    v_and_b32_dpp v16, v9, v4 row_newbcast:11 row_mask:0xf bank_mask:0xc
    v_and_b32_dpp v17, v9, v5 row_newbcast:11 row_mask:0xf bank_mask:0xc
    v_and_b32_dpp v18, v9, v6 row_newbcast:11 row_mask:0xf bank_mask:0xc
    v_and_b32_dpp v19, v9, v7 row_newbcast:11 row_mask:0xf bank_mask:0xc
    s_nop 1
    v_mfma_f32_16x16x32_bf16 v[32:35], v[16:19], v[92:95], v[32:35]
    v_and_b32_dpp v16, v8, v4 row_newbcast:4 row_mask:0xf bank_mask:0x3
    v_and_b32_dpp v17, v8, v5 row_newbcast:4 row_mask:0xf bank_mask:0x3
    v_and_b32_dpp v18, v8, v6 row_newbcast:4 row_mask:0xf bank_mask:0x3
    v_and_b32_dpp v19, v8, v7 row_newbcast:4 row_mask:0xf bank_mask:0x3
    v_and_b32_dpp v16, v8, v4 row_newbcast:5 row_mask:0xf bank_mask:0xc
    v_and_b32_dpp v17, v8, v5 row_newbcast:5 row_mask:0xf bank_mask:0xc
    v_and_b32_dpp v18, v8, v6 row_newbcast:5 row_mask:0xf bank_mask:0xc
    v_and_b32_dpp v19, v8, v7 row_newbcast:5 row_mask:0xf bank_mask:0xc
    s_nop 1
    v_mfma_f32_16x16x32_bf16 v[20:23], v[16:19], v[96:99], v[20:23]
    v_and_b32_dpp v16, v8, v4 row_newbcast:12 row_mask:0xf bank_mask:0x3
    v_and_b32_dpp v17, v8, v5 row_newbcast:12 row_mask:0xf bank_mask:0x3
    v_and_b32_dpp v18, v8, v6 row_newbcast:12 row_mask:0xf bank_mask:0x3
    v_and_b32_dpp v19, v8, v7 row_newbcast:12 row_mask:0xf bank_mask:0x3
    v_and_b32_dpp v16, v8, v4 row_newbcast:13 row_mask:0xf bank_mask:0xc
    v_and_b32_dpp v17, v8, v5 row_newbcast:13 row_mask:0xf bank_mask:0xc
    v_and_b32_dpp v18, v8, v6 row_newbcast:13 row_mask:0xf bank_mask:0xc
    v_and_b32_dpp v19, v8, v7 row_newbcast:13 row_mask:0xf bank_mask:0xc
    s_nop 1
    v_mfma_f32_16x16x32_bf16 v[24:27], v[16:19], v[96:99], v[24:27]
    v_and_b32_dpp v16, v9, v4 row_newbcast:4 row_mask:0xf bank_mask:0x3
    v_and_b32_dpp v17, v9, v5 row_newbcast:4 row_mask:0xf bank_mask:0x3
    v_and_b32_dpp v18, v9, v6 row_newbcast:4 row_mask:0xf bank_mask:0x3
    v_and_b32_dpp v19, v9, v7 row_newbcast:4 row_mask:0xf bank_mask:0x3
    v_and_b32_dpp v16, v9, v4 row_newbcast:5 row_mask:0xf bank_mask:0xc
    v_and_b32_dpp v17, v9, v5 row_newbcast:5 row_mask:0xf bank_mask:0xc
    v_and_b32_dpp v18, v9, v6 row_newbcast:5 row_mask:0xf bank_mask:0xc
    v_and_b32_dpp v19, v9, v7 row_newbcast:5 row_mask:0xf bank_mask:0xc
    s_nop 1
    v_mfma_f32_16x16x32_bf16 v[28:31], v[16:19], v[96:99], v[28:31]
    v_and_b32_dpp v16, v9, v4 row_newbcast:12 row_mask:0xf bank_mask:0x3
    v_and_b32_dpp v17, v9, v5 row_newbcast:12 row_mask:0xf bank_mask:0x3
    v_and_b32_dpp v18, v9, v6 row_newbcast:12 row_mask:0xf bank_mask:0x3
    v_and_b32_dpp v19, v9, v7 row_newbcast:12 row_mask:0xf bank_mask:0x3
    v_and_b32_dpp v16, v9, v4 row_newbcast:13 row_mask:0xf bank_mask:0xc
    v_and_b32_dpp v17, v9, v5 row_newbcast:13 row_mask:0xf bank_mask:0xc
    v_and_b32_dpp v18, v9, v6 row_newbcast:13 row_mask:0xf bank_mask:0xc
    v_and_b32_dpp v19, v9, v7 row_newbcast:13 row_mask:0xf bank_mask:0xc
    s_nop 1
    v_mfma_f32_16x16x32_bf16 v[32:35], v[16:19], v[96:99], v[32:35]
    v_and_b32_dpp v16, v8, v4 row_newbcast:6 row_mask:0xf bank_mask:0x3
    v_and_b32_dpp v17, v8, v5 row_newbcast:6 row_mask:0xf bank_mask:0x3
    v_and_b32_dpp v18, v8, v6 row_newbcast:6 row_mask:0xf bank_mask:0x3
    v_and_b32_dpp v19, v8, v7 row_newbcast:6 row_mask:0xf bank_mask:0x3
    v_and_b32_dpp v16, v8, v4 row_newbcast:7 row_mask:0xf bank_mask:0xc
    v_and_b32_dpp v17, v8, v5 row_newbcast:7 row_mask:0xf bank_mask:0xc
    v_and_b32_dpp v18, v8, v6 row_newbcast:7 row_mask:0xf bank_mask:0xc
    v_and_b32_dpp v19, v8, v7 row_newbcast:7 row_mask:0xf bank_mask:0xc
    s_nop 1
    v_mfma_f32_16x16x32_bf16 v[20:23], v[16:19], v[100:103], v[20:23]
    v_and_b32_dpp v16, v8, v4 row_newbcast:14 row_mask:0xf bank_mask:0x3
    v_and_b32_dpp v17, v8, v5 row_newbcast:14 row_mask:0xf bank_mask:0x3
    v_and_b32_dpp v18, v8, v6 row_newbcast:14 row_mask:0xf bank_mask:0x3
    v_and_b32_dpp v19, v8, v7 row_newbcast:14 row_mask:0xf bank_mask:0x3
    v_and_b32_dpp v16, v8, v4 row_newbcast:15 row_mask:0xf bank_mask:0xc
    v_and_b32_dpp v17, v8, v5 row_newbcast:15 row_mask:0xf bank_mask:0xc
    v_and_b32_dpp v18, v8, v6 row_newbcast:15 row_mask:0xf bank_mask:0xc
    v_and_b32_dpp v19, v8, v7 row_newbcast:15 row_mask:0xf bank_mask:0xc
    s_nop 1
    v_mfma_f32_16x16x32_bf16 v[24:27], v[16:19], v[100:103], v[24:27]
    v_and_b32_dpp v16, v9, v4 row_newbcast:6 row_mask:0xf bank_mask:0x3
    v_and_b32_dpp v17, v9, v5 row_newbcast:6 row_mask:0xf bank_mask:0x3
    v_and_b32_dpp v18, v9, v6 row_newbcast:6 row_mask:0xf bank_mask:0x3
    v_and_b32_dpp v19, v9, v7 row_newbcast:6 row_mask:0xf bank_mask:0x3
    v_and_b32_dpp v16, v9, v4 row_newbcast:7 row_mask:0xf bank_mask:0xc
    v_and_b32_dpp v17, v9, v5 row_newbcast:7 row_mask:0xf bank_mask:0xc
    v_and_b32_dpp v18, v9, v6 row_newbcast:7 row_mask:0xf bank_mask:0xc
    v_and_b32_dpp v19, v9, v7 row_newbcast:7 row_mask:0xf bank_mask:0xc
    s_nop 1
    v_mfma_f32_16x16x32_bf16 v[28:31], v[16:19], v[100:103], v[28:31]
    v_and_b32_dpp v16, v9, v4 row_newbcast:14 row_mask:0xf bank_mask:0x3
    v_and_b32_dpp v17, v9, v5 row_newbcast:14 row_mask:0xf bank_mask:0x3
    v_and_b32_dpp v18, v9, v6 row_newbcast:14 row_mask:0xf bank_mask:0x3
    v_and_b32_dpp v19, v9, v7 row_newbcast:14 row_mask:0xf bank_mask:0x3
    v_and_b32_dpp v16, v9, v4 row_newbcast:15 row_mask:0xf bank_mask:0xc
    v_and_b32_dpp v17, v9, v5 row_newbcast:15 row_mask:0xf bank_mask:0xc
    v_and_b32_dpp v18, v9, v6 row_newbcast:15 row_mask:0xf bank_mask:0xc
    v_and_b32_dpp v19, v9, v7 row_newbcast:15 row_mask:0xf bank_mask:0xc
    s_nop 1
    v_mfma_f32_16x16x32_bf16 v[32:35], v[16:19], v[100:103], v[32:35]
    v_perm_b32 v8, v39, v39, s64
    v_perm_b32 v9, v39, v39, s65
    s_nop 1
    v_and_b32_dpp v16, v8, v4 row_newbcast:0 row_mask:0xf bank_mask:0x3
    v_and_b32_dpp v17, v8, v5 row_newbcast:0 row_mask:0xf bank_mask:0x3
    v_and_b32_dpp v18, v8, v6 row_newbcast:0 row_mask:0xf bank_mask:0x3
    v_and_b32_dpp v19, v8, v7 row_newbcast:0 row_mask:0xf bank_mask:0x3
    v_and_b32_dpp v16, v8, v4 row_newbcast:1 row_mask:0xf bank_mask:0xc
    v_and_b32_dpp v17, v8, v5 row_newbcast:1 row_mask:0xf bank_mask:0xc
    v_and_b32_dpp v18, v8, v6 row_newbcast:1 row_mask:0xf bank_mask:0xc
    v_and_b32_dpp v19, v8, v7 row_newbcast:1 row_mask:0xf bank_mask:0xc
    s_nop 1
    v_mfma_f32_16x16x32_bf16 v[20:23], v[16:19], v[104:107], v[20:23]
    v_and_b32_dpp v16, v8, v4 row_newbcast:8 row_mask:0xf bank_mask:0x3
    v_and_b32_dpp v17, v8, v5 row_newbcast:8 row_mask:0xf bank_mask:0x3
    v_and_b32_dpp v18, v8, v6 row_newbcast:8 row_mask:0xf bank_mask:0x3
    v_and_b32_dpp v19, v8, v7 row_newbcast:8 row_mask:0xf bank_mask:0x3
    v_and_b32_dpp v16, v8, v4 row_newbcast:9 row_mask:0xf bank_mask:0xc
    v_and_b32_dpp v17, v8, v5 row_newbcast:9 row_mask:0xf bank_mask:0xc
    v_and_b32_dpp v18, v8, v6 row_newbcast:9 row_mask:0xf bank_mask:0xc
    v_and_b32_dpp v19, v8, v7 row_newbcast:9 row_mask:0xf bank_mask:0xc
    s_nop 1
    v_mfma_f32_16x16x32_bf16 v[24:27], v[16:19], v[104:107], v[24:27]
    v_and_b32_dpp v16, v9, v4 row_newbcast:0 row_mask:0xf bank_mask:0x3
    v_and_b32_dpp v17, v9, v5 row_newbcast:0 row_mask:0xf bank_mask:0x3
    v_and_b32_dpp v18, v9, v6 row_newbcast:0 row_mask:0xf bank_mask:0x3
    v_and_b32_dpp v19, v9, v7 row_newbcast:0 row_mask:0xf bank_mask:0x3
    v_and_b32_dpp v16, v9, v4 row_newbcast:1 row_mask:0xf bank_mask:0xc
    v_and_b32_dpp v17, v9, v5 row_newbcast:1 row_mask:0xf bank_mask:0xc
    v_and_b32_dpp v18, v9, v6 row_newbcast:1 row_mask:0xf bank_mask:0xc
    v_and_b32_dpp v19, v9, v7 row_newbcast:1 row_mask:0xf bank_mask:0xc
    s_nop 1
    v_mfma_f32_16x16x32_bf16 v[28:31], v[16:19], v[104:107], v[28:31]
    v_and_b32_dpp v16, v9, v4 row_newbcast:8 row_mask:0xf bank_mask:0x3
    v_and_b32_dpp v17, v9, v5 row_newbcast:8 row_mask:0xf bank_mask:0x3
    v_and_b32_dpp v18, v9, v6 row_newbcast:8 row_mask:0xf bank_mask:0x3
    v_and_b32_dpp v19, v9, v7 row_newbcast:8 row_mask:0xf bank_mask:0x3
    v_and_b32_dpp v16, v9, v4 row_newbcast:9 row_mask:0xf bank_mask:0xc
    v_and_b32_dpp v17, v9, v5 row_newbcast:9 row_mask:0xf bank_mask:0xc
    v_and_b32_dpp v18, v9, v6 row_newbcast:9 row_mask:0xf bank_mask:0xc
    v_and_b32_dpp v19, v9, v7 row_newbcast:9 row_mask:0xf bank_mask:0xc
    s_nop 1
    v_mfma_f32_16x16x32_bf16 v[32:35], v[16:19], v[104:107], v[32:35]
    v_and_b32_dpp v16, v8, v4 row_newbcast:2 row_mask:0xf bank_mask:0x3
    v_and_b32_dpp v17, v8, v5 row_newbcast:2 row_mask:0xf bank_mask:0x3
    v_and_b32_dpp v18, v8, v6 row_newbcast:2 row_mask:0xf bank_mask:0x3
    v_and_b32_dpp v19, v8, v7 row_newbcast:2 row_mask:0xf bank_mask:0x3
    v_and_b32_dpp v16, v8, v4 row_newbcast:3 row_mask:0xf bank_mask:0xc
    v_and_b32_dpp v17, v8, v5 row_newbcast:3 row_mask:0xf bank_mask:0xc
    v_and_b32_dpp v18, v8, v6 row_newbcast:3 row_mask:0xf bank_mask:0xc
    v_and_b32_dpp v19, v8, v7 row_newbcast:3 row_mask:0xf bank_mask:0xc
    s_nop 1
    v_mfma_f32_16x16x32_bf16 v[20:23], v[16:19], v[108:111], v[20:23]
    v_and_b32_dpp v16, v8, v4 row_newbcast:10 row_mask:0xf bank_mask:0x3
    v_and_b32_dpp v17, v8, v5 row_newbcast:10 row_mask:0xf bank_mask:0x3
    v_and_b32_dpp v18, v8, v6 row_newbcast:10 row_mask:0xf bank_mask:0x3
    v_and_b32_dpp v19, v8, v7 row_newbcast:10 row_mask:0xf bank_mask:0x3
    v_and_b32_dpp v16, v8, v4 row_newbcast:11 row_mask:0xf bank_mask:0xc
    v_and_b32_dpp v17, v8, v5 row_newbcast:11 row_mask:0xf bank_mask:0xc
    v_and_b32_dpp v18, v8, v6 row_newbcast:11 row_mask:0xf bank_mask:0xc
    v_and_b32_dpp v19, v8, v7 row_newbcast:11 row_mask:0xf bank_mask:0xc
    s_nop 1
    v_mfma_f32_16x16x32_bf16 v[24:27], v[16:19], v[108:111], v[24:27]
    v_and_b32_dpp v16, v9, v4 row_newbcast:2 row_mask:0xf bank_mask:0x3
    v_and_b32_dpp v17, v9, v5 row_newbcast:2 row_mask:0xf bank_mask:0x3
    v_and_b32_dpp v18, v9, v6 row_newbcast:2 row_mask:0xf bank_mask:0x3
    v_and_b32_dpp v19, v9, v7 row_newbcast:2 row_mask:0xf bank_mask:0x3
    v_and_b32_dpp v16, v9, v4 row_newbcast:3 row_mask:0xf bank_mask:0xc
    v_and_b32_dpp v17, v9, v5 row_newbcast:3 row_mask:0xf bank_mask:0xc
    v_and_b32_dpp v18, v9, v6 row_newbcast:3 row_mask:0xf bank_mask:0xc
    v_and_b32_dpp v19, v9, v7 row_newbcast:3 row_mask:0xf bank_mask:0xc
    s_nop 1
    v_mfma_f32_16x16x32_bf16 v[28:31], v[16:19], v[108:111], v[28:31]
    v_and_b32_dpp v16, v9, v4 row_newbcast:10 row_mask:0xf bank_mask:0x3
    v_and_b32_dpp v17, v9, v5 row_newbcast:10 row_mask:0xf bank_mask:0x3
    v_and_b32_dpp v18, v9, v6 row_newbcast:10 row_mask:0xf bank_mask:0x3
    v_and_b32_dpp v19, v9, v7 row_newbcast:10 row_mask:0xf bank_mask:0x3
    v_and_b32_dpp v16, v9, v4 row_newbcast:11 row_mask:0xf bank_mask:0xc
    v_and_b32_dpp v17, v9, v5 row_newbcast:11 row_mask:0xf bank_mask:0xc
    v_and_b32_dpp v18, v9, v6 row_newbcast:11 row_mask:0xf bank_mask:0xc
    v_and_b32_dpp v19, v9, v7 row_newbcast:11 row_mask:0xf bank_mask:0xc
    s_nop 1
    v_mfma_f32_16x16x32_bf16 v[32:35], v[16:19], v[108:111], v[32:35]
    v_and_b32_dpp v16, v8, v4 row_newbcast:4 row_mask:0xf bank_mask:0x3
    v_and_b32_dpp v17, v8, v5 row_newbcast:4 row_mask:0xf bank_mask:0x3
    v_and_b32_dpp v18, v8, v6 row_newbcast:4 row_mask:0xf bank_mask:0x3
    v_and_b32_dpp v19, v8, v7 row_newbcast:4 row_mask:0xf bank_mask:0x3
    v_and_b32_dpp v16, v8, v4 row_newbcast:5 row_mask:0xf bank_mask:0xc
    v_and_b32_dpp v17, v8, v5 row_newbcast:5 row_mask:0xf bank_mask:0xc
    v_and_b32_dpp v18, v8, v6 row_newbcast:5 row_mask:0xf bank_mask:0xc
    v_and_b32_dpp v19, v8, v7 row_newbcast:5 row_mask:0xf bank_mask:0xc
    s_nop 1
    v_mfma_f32_16x16x32_bf16 v[20:23], v[16:19], v[112:115], v[20:23]
    v_and_b32_dpp v16, v8, v4 row_newbcast:12 row_mask:0xf bank_mask:0x3
    v_and_b32_dpp v17, v8, v5 row_newbcast:12 row_mask:0xf bank_mask:0x3
    v_and_b32_dpp v18, v8, v6 row_newbcast:12 row_mask:0xf bank_mask:0x3
    v_and_b32_dpp v19, v8, v7 row_newbcast:12 row_mask:0xf bank_mask:0x3
    v_and_b32_dpp v16, v8, v4 row_newbcast:13 row_mask:0xf bank_mask:0xc
    v_and_b32_dpp v17, v8, v5 row_newbcast:13 row_mask:0xf bank_mask:0xc
    v_and_b32_dpp v18, v8, v6 row_newbcast:13 row_mask:0xf bank_mask:0xc
    v_and_b32_dpp v19, v8, v7 row_newbcast:13 row_mask:0xf bank_mask:0xc
    s_nop 1
    v_mfma_f32_16x16x32_bf16 v[24:27], v[16:19], v[112:115], v[24:27]
    v_and_b32_dpp v16, v9, v4 row_newbcast:4 row_mask:0xf bank_mask:0x3
    v_and_b32_dpp v17, v9, v5 row_newbcast:4 row_mask:0xf bank_mask:0x3
    v_and_b32_dpp v18, v9, v6 row_newbcast:4 row_mask:0xf bank_mask:0x3
    v_and_b32_dpp v19, v9, v7 row_newbcast:4 row_mask:0xf bank_mask:0x3
    v_and_b32_dpp v16, v9, v4 row_newbcast:5 row_mask:0xf bank_mask:0xc
    v_and_b32_dpp v17, v9, v5 row_newbcast:5 row_mask:0xf bank_mask:0xc
    v_and_b32_dpp v18, v9, v6 row_newbcast:5 row_mask:0xf bank_mask:0xc
    v_and_b32_dpp v19, v9, v7 row_newbcast:5 row_mask:0xf bank_mask:0xc
    s_nop 1
    v_mfma_f32_16x16x32_bf16 v[28:31], v[16:19], v[112:115], v[28:31]
    v_and_b32_dpp v16, v9, v4 row_newbcast:12 row_mask:0xf bank_mask:0x3
    v_and_b32_dpp v17, v9, v5 row_newbcast:12 row_mask:0xf bank_mask:0x3
    v_and_b32_dpp v18, v9, v6 row_newbcast:12 row_mask:0xf bank_mask:0x3
    v_and_b32_dpp v19, v9, v7 row_newbcast:12 row_mask:0xf bank_mask:0x3
    v_and_b32_dpp v16, v9, v4 row_newbcast:13 row_mask:0xf bank_mask:0xc
    v_and_b32_dpp v17, v9, v5 row_newbcast:13 row_mask:0xf bank_mask:0xc
    v_and_b32_dpp v18, v9, v6 row_newbcast:13 row_mask:0xf bank_mask:0xc
    v_and_b32_dpp v19, v9, v7 row_newbcast:13 row_mask:0xf bank_mask:0xc
    s_nop 1
    v_mfma_f32_16x16x32_bf16 v[32:35], v[16:19], v[112:115], v[32:35]
    v_and_b32_dpp v16, v8, v4 row_newbcast:6 row_mask:0xf bank_mask:0x3
    v_and_b32_dpp v17, v8, v5 row_newbcast:6 row_mask:0xf bank_mask:0x3
    v_and_b32_dpp v18, v8, v6 row_newbcast:6 row_mask:0xf bank_mask:0x3
    v_and_b32_dpp v19, v8, v7 row_newbcast:6 row_mask:0xf bank_mask:0x3
    v_and_b32_dpp v16, v8, v4 row_newbcast:7 row_mask:0xf bank_mask:0xc
    v_and_b32_dpp v17, v8, v5 row_newbcast:7 row_mask:0xf bank_mask:0xc
    v_and_b32_dpp v18, v8, v6 row_newbcast:7 row_mask:0xf bank_mask:0xc
    v_and_b32_dpp v19, v8, v7 row_newbcast:7 row_mask:0xf bank_mask:0xc
    s_nop 1
    v_mfma_f32_16x16x32_bf16 v[20:23], v[16:19], v[116:119], v[20:23]
    v_and_b32_dpp v16, v8, v4 row_newbcast:14 row_mask:0xf bank_mask:0x3
    v_and_b32_dpp v17, v8, v5 row_newbcast:14 row_mask:0xf bank_mask:0x3
    v_and_b32_dpp v18, v8, v6 row_newbcast:14 row_mask:0xf bank_mask:0x3
    v_and_b32_dpp v19, v8, v7 row_newbcast:14 row_mask:0xf bank_mask:0x3
    v_and_b32_dpp v16, v8, v4 row_newbcast:15 row_mask:0xf bank_mask:0xc
    v_and_b32_dpp v17, v8, v5 row_newbcast:15 row_mask:0xf bank_mask:0xc
    v_and_b32_dpp v18, v8, v6 row_newbcast:15 row_mask:0xf bank_mask:0xc
    v_and_b32_dpp v19, v8, v7 row_newbcast:15 row_mask:0xf bank_mask:0xc
    s_nop 1
    v_mfma_f32_16x16x32_bf16 v[24:27], v[16:19], v[116:119], v[24:27]
    v_and_b32_dpp v16, v9, v4 row_newbcast:6 row_mask:0xf bank_mask:0x3
    v_and_b32_dpp v17, v9, v5 row_newbcast:6 row_mask:0xf bank_mask:0x3
    v_and_b32_dpp v18, v9, v6 row_newbcast:6 row_mask:0xf bank_mask:0x3
    v_and_b32_dpp v19, v9, v7 row_newbcast:6 row_mask:0xf bank_mask:0x3
    v_and_b32_dpp v16, v9, v4 row_newbcast:7 row_mask:0xf bank_mask:0xc
    v_and_b32_dpp v17, v9, v5 row_newbcast:7 row_mask:0xf bank_mask:0xc
    v_and_b32_dpp v18, v9, v6 row_newbcast:7 row_mask:0xf bank_mask:0xc
    v_and_b32_dpp v19, v9, v7 row_newbcast:7 row_mask:0xf bank_mask:0xc
    s_nop 1
    v_mfma_f32_16x16x32_bf16 v[28:31], v[16:19], v[116:119], v[28:31]
    v_and_b32_dpp v16, v9, v4 row_newbcast:14 row_mask:0xf bank_mask:0x3
    v_and_b32_dpp v17, v9, v5 row_newbcast:14 row_mask:0xf bank_mask:0x3
    v_and_b32_dpp v18, v9, v6 row_newbcast:14 row_mask:0xf bank_mask:0x3
    v_and_b32_dpp v19, v9, v7 row_newbcast:14 row_mask:0xf bank_mask:0x3
    v_and_b32_dpp v16, v9, v4 row_newbcast:15 row_mask:0xf bank_mask:0xc
    v_and_b32_dpp v17, v9, v5 row_newbcast:15 row_mask:0xf bank_mask:0xc
    v_and_b32_dpp v18, v9, v6 row_newbcast:15 row_mask:0xf bank_mask:0xc
    v_and_b32_dpp v19, v9, v7 row_newbcast:15 row_mask:0xf bank_mask:0xc
    s_nop 1
    v_mfma_f32_16x16x32_bf16 v[32:35], v[16:19], v[116:119], v[32:35]
    v_perm_b32 v8, v40, v40, s64
    v_perm_b32 v9, v40, v40, s65
    s_nop 1
    v_and_b32_dpp v16, v8, v4 row_newbcast:0 row_mask:0xf bank_mask:0x3
    v_and_b32_dpp v17, v8, v5 row_newbcast:0 row_mask:0xf bank_mask:0x3
    v_and_b32_dpp v18, v8, v6 row_newbcast:0 row_mask:0xf bank_mask:0x3
    v_and_b32_dpp v19, v8, v7 row_newbcast:0 row_mask:0xf bank_mask:0x3
    v_and_b32_dpp v16, v8, v4 row_newbcast:1 row_mask:0xf bank_mask:0xc
    v_and_b32_dpp v17, v8, v5 row_newbcast:1 row_mask:0xf bank_mask:0xc
    v_and_b32_dpp v18, v8, v6 row_newbcast:1 row_mask:0xf bank_mask:0xc
    v_and_b32_dpp v19, v8, v7 row_newbcast:1 row_mask:0xf bank_mask:0xc
    s_nop 1
    v_mfma_f32_16x16x32_bf16 v[20:23], v[16:19], v[120:123], v[20:23]
    v_and_b32_dpp v16, v8, v4 row_newbcast:8 row_mask:0xf bank_mask:0x3
    v_and_b32_dpp v17, v8, v5 row_newbcast:8 row_mask:0xf bank_mask:0x3
    v_and_b32_dpp v18, v8, v6 row_newbcast:8 row_mask:0xf bank_mask:0x3
    v_and_b32_dpp v19, v8, v7 row_newbcast:8 row_mask:0xf bank_mask:0x3
    v_and_b32_dpp v16, v8, v4 row_newbcast:9 row_mask:0xf bank_mask:0xc
    v_and_b32_dpp v17, v8, v5 row_newbcast:9 row_mask:0xf bank_mask:0xc
    v_and_b32_dpp v18, v8, v6 row_newbcast:9 row_mask:0xf bank_mask:0xc
    v_and_b32_dpp v19, v8, v7 row_newbcast:9 row_mask:0xf bank_mask:0xc
    s_nop 1
    v_mfma_f32_16x16x32_bf16 v[24:27], v[16:19], v[120:123], v[24:27]
    v_and_b32_dpp v16, v9, v4 row_newbcast:0 row_mask:0xf bank_mask:0x3
    v_and_b32_dpp v17, v9, v5 row_newbcast:0 row_mask:0xf bank_mask:0x3
    v_and_b32_dpp v18, v9, v6 row_newbcast:0 row_mask:0xf bank_mask:0x3
    v_and_b32_dpp v19, v9, v7 row_newbcast:0 row_mask:0xf bank_mask:0x3
    v_and_b32_dpp v16, v9, v4 row_newbcast:1 row_mask:0xf bank_mask:0xc
    v_and_b32_dpp v17, v9, v5 row_newbcast:1 row_mask:0xf bank_mask:0xc
    v_and_b32_dpp v18, v9, v6 row_newbcast:1 row_mask:0xf bank_mask:0xc
    v_and_b32_dpp v19, v9, v7 row_newbcast:1 row_mask:0xf bank_mask:0xc
    s_nop 1
    v_mfma_f32_16x16x32_bf16 v[28:31], v[16:19], v[120:123], v[28:31]
    v_and_b32_dpp v16, v9, v4 row_newbcast:8 row_mask:0xf bank_mask:0x3
    v_and_b32_dpp v17, v9, v5 row_newbcast:8 row_mask:0xf bank_mask:0x3
    v_and_b32_dpp v18, v9, v6 row_newbcast:8 row_mask:0xf bank_mask:0x3
    v_and_b32_dpp v19, v9, v7 row_newbcast:8 row_mask:0xf bank_mask:0x3
    v_and_b32_dpp v16, v9, v4 row_newbcast:9 row_mask:0xf bank_mask:0xc
    v_and_b32_dpp v17, v9, v5 row_newbcast:9 row_mask:0xf bank_mask:0xc
    v_and_b32_dpp v18, v9, v6 row_newbcast:9 row_mask:0xf bank_mask:0xc
    v_and_b32_dpp v19, v9, v7 row_newbcast:9 row_mask:0xf bank_mask:0xc
    s_nop 1
    v_mfma_f32_16x16x32_bf16 v[32:35], v[16:19], v[120:123], v[32:35]
    v_and_b32_dpp v16, v8, v4 row_newbcast:2 row_mask:0xf bank_mask:0x3
    v_and_b32_dpp v17, v8, v5 row_newbcast:2 row_mask:0xf bank_mask:0x3
    v_and_b32_dpp v18, v8, v6 row_newbcast:2 row_mask:0xf bank_mask:0x3
    v_and_b32_dpp v19, v8, v7 row_newbcast:2 row_mask:0xf bank_mask:0x3
    v_and_b32_dpp v16, v8, v4 row_newbcast:3 row_mask:0xf bank_mask:0xc
    v_and_b32_dpp v17, v8, v5 row_newbcast:3 row_mask:0xf bank_mask:0xc
    v_and_b32_dpp v18, v8, v6 row_newbcast:3 row_mask:0xf bank_mask:0xc
    v_and_b32_dpp v19, v8, v7 row_newbcast:3 row_mask:0xf bank_mask:0xc
    s_nop 1
    v_mfma_f32_16x16x32_bf16 v[20:23], v[16:19], v[124:127], v[20:23]
    v_and_b32_dpp v16, v8, v4 row_newbcast:10 row_mask:0xf bank_mask:0x3
    v_and_b32_dpp v17, v8, v5 row_newbcast:10 row_mask:0xf bank_mask:0x3
    v_and_b32_dpp v18, v8, v6 row_newbcast:10 row_mask:0xf bank_mask:0x3
    v_and_b32_dpp v19, v8, v7 row_newbcast:10 row_mask:0xf bank_mask:0x3
    v_and_b32_dpp v16, v8, v4 row_newbcast:11 row_mask:0xf bank_mask:0xc
    v_and_b32_dpp v17, v8, v5 row_newbcast:11 row_mask:0xf bank_mask:0xc
    v_and_b32_dpp v18, v8, v6 row_newbcast:11 row_mask:0xf bank_mask:0xc
    v_and_b32_dpp v19, v8, v7 row_newbcast:11 row_mask:0xf bank_mask:0xc
    s_nop 1
    v_mfma_f32_16x16x32_bf16 v[24:27], v[16:19], v[124:127], v[24:27]
    v_and_b32_dpp v16, v9, v4 row_newbcast:2 row_mask:0xf bank_mask:0x3
    v_and_b32_dpp v17, v9, v5 row_newbcast:2 row_mask:0xf bank_mask:0x3
    v_and_b32_dpp v18, v9, v6 row_newbcast:2 row_mask:0xf bank_mask:0x3
    v_and_b32_dpp v19, v9, v7 row_newbcast:2 row_mask:0xf bank_mask:0x3
    v_and_b32_dpp v16, v9, v4 row_newbcast:3 row_mask:0xf bank_mask:0xc
    v_and_b32_dpp v17, v9, v5 row_newbcast:3 row_mask:0xf bank_mask:0xc
    v_and_b32_dpp v18, v9, v6 row_newbcast:3 row_mask:0xf bank_mask:0xc
    v_and_b32_dpp v19, v9, v7 row_newbcast:3 row_mask:0xf bank_mask:0xc
    s_nop 1
    v_mfma_f32_16x16x32_bf16 v[28:31], v[16:19], v[124:127], v[28:31]
    v_and_b32_dpp v16, v9, v4 row_newbcast:10 row_mask:0xf bank_mask:0x3
    v_and_b32_dpp v17, v9, v5 row_newbcast:10 row_mask:0xf bank_mask:0x3
    v_and_b32_dpp v18, v9, v6 row_newbcast:10 row_mask:0xf bank_mask:0x3
    v_and_b32_dpp v19, v9, v7 row_newbcast:10 row_mask:0xf bank_mask:0x3
    v_and_b32_dpp v16, v9, v4 row_newbcast:11 row_mask:0xf bank_mask:0xc
    v_and_b32_dpp v17, v9, v5 row_newbcast:11 row_mask:0xf bank_mask:0xc
    v_and_b32_dpp v18, v9, v6 row_newbcast:11 row_mask:0xf bank_mask:0xc
    v_and_b32_dpp v19, v9, v7 row_newbcast:11 row_mask:0xf bank_mask:0xc
    s_nop 1
    v_mfma_f32_16x16x32_bf16 v[32:35], v[16:19], v[124:127], v[32:35]
    v_and_b32_dpp v16, v8, v4 row_newbcast:4 row_mask:0xf bank_mask:0x3
    v_and_b32_dpp v17, v8, v5 row_newbcast:4 row_mask:0xf bank_mask:0x3
    v_and_b32_dpp v18, v8, v6 row_newbcast:4 row_mask:0xf bank_mask:0x3
    v_and_b32_dpp v19, v8, v7 row_newbcast:4 row_mask:0xf bank_mask:0x3
    v_and_b32_dpp v16, v8, v4 row_newbcast:5 row_mask:0xf bank_mask:0xc
    v_and_b32_dpp v17, v8, v5 row_newbcast:5 row_mask:0xf bank_mask:0xc
    v_and_b32_dpp v18, v8, v6 row_newbcast:5 row_mask:0xf bank_mask:0xc
    v_and_b32_dpp v19, v8, v7 row_newbcast:5 row_mask:0xf bank_mask:0xc
    s_nop 1
    v_mfma_f32_16x16x32_bf16 v[20:23], v[16:19], v[128:131], v[20:23]
    v_and_b32_dpp v16, v8, v4 row_newbcast:12 row_mask:0xf bank_mask:0x3
    v_and_b32_dpp v17, v8, v5 row_newbcast:12 row_mask:0xf bank_mask:0x3
    v_and_b32_dpp v18, v8, v6 row_newbcast:12 row_mask:0xf bank_mask:0x3
    v_and_b32_dpp v19, v8, v7 row_newbcast:12 row_mask:0xf bank_mask:0x3
    v_and_b32_dpp v16, v8, v4 row_newbcast:13 row_mask:0xf bank_mask:0xc
    v_and_b32_dpp v17, v8, v5 row_newbcast:13 row_mask:0xf bank_mask:0xc
    v_and_b32_dpp v18, v8, v6 row_newbcast:13 row_mask:0xf bank_mask:0xc
    v_and_b32_dpp v19, v8, v7 row_newbcast:13 row_mask:0xf bank_mask:0xc
    s_nop 1
    v_mfma_f32_16x16x32_bf16 v[24:27], v[16:19], v[128:131], v[24:27]
    v_and_b32_dpp v16, v9, v4 row_newbcast:4 row_mask:0xf bank_mask:0x3
    v_and_b32_dpp v17, v9, v5 row_newbcast:4 row_mask:0xf bank_mask:0x3
    v_and_b32_dpp v18, v9, v6 row_newbcast:4 row_mask:0xf bank_mask:0x3
    v_and_b32_dpp v19, v9, v7 row_newbcast:4 row_mask:0xf bank_mask:0x3
    v_and_b32_dpp v16, v9, v4 row_newbcast:5 row_mask:0xf bank_mask:0xc
    v_and_b32_dpp v17, v9, v5 row_newbcast:5 row_mask:0xf bank_mask:0xc
    v_and_b32_dpp v18, v9, v6 row_newbcast:5 row_mask:0xf bank_mask:0xc
    v_and_b32_dpp v19, v9, v7 row_newbcast:5 row_mask:0xf bank_mask:0xc
    s_nop 1
    v_mfma_f32_16x16x32_bf16 v[28:31], v[16:19], v[128:131], v[28:31]
    v_and_b32_dpp v16, v9, v4 row_newbcast:12 row_mask:0xf bank_mask:0x3
    v_and_b32_dpp v17, v9, v5 row_newbcast:12 row_mask:0xf bank_mask:0x3
    v_and_b32_dpp v18, v9, v6 row_newbcast:12 row_mask:0xf bank_mask:0x3
    v_and_b32_dpp v19, v9, v7 row_newbcast:12 row_mask:0xf bank_mask:0x3
    v_and_b32_dpp v16, v9, v4 row_newbcast:13 row_mask:0xf bank_mask:0xc
    v_and_b32_dpp v17, v9, v5 row_newbcast:13 row_mask:0xf bank_mask:0xc
    v_and_b32_dpp v18, v9, v6 row_newbcast:13 row_mask:0xf bank_mask:0xc
    v_and_b32_dpp v19, v9, v7 row_newbcast:13 row_mask:0xf bank_mask:0xc
    s_nop 1
    v_mfma_f32_16x16x32_bf16 v[32:35], v[16:19], v[128:131], v[32:35]
    v_and_b32_dpp v16, v8, v4 row_newbcast:6 row_mask:0xf bank_mask:0x3
    v_and_b32_dpp v17, v8, v5 row_newbcast:6 row_mask:0xf bank_mask:0x3
    v_and_b32_dpp v18, v8, v6 row_newbcast:6 row_mask:0xf bank_mask:0x3
    v_and_b32_dpp v19, v8, v7 row_newbcast:6 row_mask:0xf bank_mask:0x3
    v_and_b32_dpp v16, v8, v4 row_newbcast:7 row_mask:0xf bank_mask:0xc
    v_and_b32_dpp v17, v8, v5 row_newbcast:7 row_mask:0xf bank_mask:0xc
    v_and_b32_dpp v18, v8, v6 row_newbcast:7 row_mask:0xf bank_mask:0xc
    v_and_b32_dpp v19, v8, v7 row_newbcast:7 row_mask:0xf bank_mask:0xc
    s_nop 1
    v_mfma_f32_16x16x32_bf16 v[20:23], v[16:19], v[132:135], v[20:23]
    v_and_b32_dpp v16, v8, v4 row_newbcast:14 row_mask:0xf bank_mask:0x3
    v_and_b32_dpp v17, v8, v5 row_newbcast:14 row_mask:0xf bank_mask:0x3
    v_and_b32_dpp v18, v8, v6 row_newbcast:14 row_mask:0xf bank_mask:0x3
    v_and_b32_dpp v19, v8, v7 row_newbcast:14 row_mask:0xf bank_mask:0x3
    v_and_b32_dpp v16, v8, v4 row_newbcast:15 row_mask:0xf bank_mask:0xc
    v_and_b32_dpp v17, v8, v5 row_newbcast:15 row_mask:0xf bank_mask:0xc
    v_and_b32_dpp v18, v8, v6 row_newbcast:15 row_mask:0xf bank_mask:0xc
    v_and_b32_dpp v19, v8, v7 row_newbcast:15 row_mask:0xf bank_mask:0xc
    s_nop 1
    v_mfma_f32_16x16x32_bf16 v[24:27], v[16:19], v[132:135], v[24:27]
    v_and_b32_dpp v16, v9, v4 row_newbcast:6 row_mask:0xf bank_mask:0x3
    v_and_b32_dpp v17, v9, v5 row_newbcast:6 row_mask:0xf bank_mask:0x3
    v_and_b32_dpp v18, v9, v6 row_newbcast:6 row_mask:0xf bank_mask:0x3
    v_and_b32_dpp v19, v9, v7 row_newbcast:6 row_mask:0xf bank_mask:0x3
    v_and_b32_dpp v16, v9, v4 row_newbcast:7 row_mask:0xf bank_mask:0xc
    v_and_b32_dpp v17, v9, v5 row_newbcast:7 row_mask:0xf bank_mask:0xc
    v_and_b32_dpp v18, v9, v6 row_newbcast:7 row_mask:0xf bank_mask:0xc
    v_and_b32_dpp v19, v9, v7 row_newbcast:7 row_mask:0xf bank_mask:0xc
    s_nop 1
    v_mfma_f32_16x16x32_bf16 v[28:31], v[16:19], v[132:135], v[28:31]
    v_and_b32_dpp v16, v9, v4 row_newbcast:14 row_mask:0xf bank_mask:0x3
    v_and_b32_dpp v17, v9, v5 row_newbcast:14 row_mask:0xf bank_mask:0x3
    v_and_b32_dpp v18, v9, v6 row_newbcast:14 row_mask:0xf bank_mask:0x3
    v_and_b32_dpp v19, v9, v7 row_newbcast:14 row_mask:0xf bank_mask:0x3
    v_and_b32_dpp v16, v9, v4 row_newbcast:15 row_mask:0xf bank_mask:0xc
    v_and_b32_dpp v17, v9, v5 row_newbcast:15 row_mask:0xf bank_mask:0xc
    v_and_b32_dpp v18, v9, v6 row_newbcast:15 row_mask:0xf bank_mask:0xc
    v_and_b32_dpp v19, v9, v7 row_newbcast:15 row_mask:0xf bank_mask:0xc
    s_nop 1
    v_mfma_f32_16x16x32_bf16 v[32:35], v[16:19], v[132:135], v[32:35]
    v_perm_b32 v8, v41, v41, s64
    v_perm_b32 v9, v41, v41, s65
    s_nop 1
    v_and_b32_dpp v16, v8, v4 row_newbcast:0 row_mask:0xf bank_mask:0x3
    v_and_b32_dpp v17, v8, v5 row_newbcast:0 row_mask:0xf bank_mask:0x3
    v_and_b32_dpp v18, v8, v6 row_newbcast:0 row_mask:0xf bank_mask:0x3
    v_and_b32_dpp v19, v8, v7 row_newbcast:0 row_mask:0xf bank_mask:0x3
    v_and_b32_dpp v16, v8, v4 row_newbcast:1 row_mask:0xf bank_mask:0xc
    v_and_b32_dpp v17, v8, v5 row_newbcast:1 row_mask:0xf bank_mask:0xc
    v_and_b32_dpp v18, v8, v6 row_newbcast:1 row_mask:0xf bank_mask:0xc
    v_and_b32_dpp v19, v8, v7 row_newbcast:1 row_mask:0xf bank_mask:0xc
    s_nop 1
    v_mfma_f32_16x16x32_bf16 v[20:23], v[16:19], v[136:139], v[20:23]
    v_and_b32_dpp v16, v8, v4 row_newbcast:8 row_mask:0xf bank_mask:0x3
    v_and_b32_dpp v17, v8, v5 row_newbcast:8 row_mask:0xf bank_mask:0x3
    v_and_b32_dpp v18, v8, v6 row_newbcast:8 row_mask:0xf bank_mask:0x3
    v_and_b32_dpp v19, v8, v7 row_newbcast:8 row_mask:0xf bank_mask:0x3
    v_and_b32_dpp v16, v8, v4 row_newbcast:9 row_mask:0xf bank_mask:0xc
    v_and_b32_dpp v17, v8, v5 row_newbcast:9 row_mask:0xf bank_mask:0xc
    v_and_b32_dpp v18, v8, v6 row_newbcast:9 row_mask:0xf bank_mask:0xc
    v_and_b32_dpp v19, v8, v7 row_newbcast:9 row_mask:0xf bank_mask:0xc
    s_nop 1
    v_mfma_f32_16x16x32_bf16 v[24:27], v[16:19], v[136:139], v[24:27]
    v_and_b32_dpp v16, v9, v4 row_newbcast:0 row_mask:0xf bank_mask:0x3
    v_and_b32_dpp v17, v9, v5 row_newbcast:0 row_mask:0xf bank_mask:0x3
    v_and_b32_dpp v18, v9, v6 row_newbcast:0 row_mask:0xf bank_mask:0x3
    v_and_b32_dpp v19, v9, v7 row_newbcast:0 row_mask:0xf bank_mask:0x3
    v_and_b32_dpp v16, v9, v4 row_newbcast:1 row_mask:0xf bank_mask:0xc
    v_and_b32_dpp v17, v9, v5 row_newbcast:1 row_mask:0xf bank_mask:0xc
    v_and_b32_dpp v18, v9, v6 row_newbcast:1 row_mask:0xf bank_mask:0xc
    v_and_b32_dpp v19, v9, v7 row_newbcast:1 row_mask:0xf bank_mask:0xc
    s_nop 1
    v_mfma_f32_16x16x32_bf16 v[28:31], v[16:19], v[136:139], v[28:31]
    v_and_b32_dpp v16, v9, v4 row_newbcast:8 row_mask:0xf bank_mask:0x3
    v_and_b32_dpp v17, v9, v5 row_newbcast:8 row_mask:0xf bank_mask:0x3
    v_and_b32_dpp v18, v9, v6 row_newbcast:8 row_mask:0xf bank_mask:0x3
    v_and_b32_dpp v19, v9, v7 row_newbcast:8 row_mask:0xf bank_mask:0x3
    v_and_b32_dpp v16, v9, v4 row_newbcast:9 row_mask:0xf bank_mask:0xc
    v_and_b32_dpp v17, v9, v5 row_newbcast:9 row_mask:0xf bank_mask:0xc
    v_and_b32_dpp v18, v9, v6 row_newbcast:9 row_mask:0xf bank_mask:0xc
    v_and_b32_dpp v19, v9, v7 row_newbcast:9 row_mask:0xf bank_mask:0xc
    s_nop 1
    v_mfma_f32_16x16x32_bf16 v[32:35], v[16:19], v[136:139], v[32:35]
    v_and_b32_dpp v16, v8, v4 row_newbcast:2 row_mask:0xf bank_mask:0x3
    v_and_b32_dpp v17, v8, v5 row_newbcast:2 row_mask:0xf bank_mask:0x3
    v_and_b32_dpp v18, v8, v6 row_newbcast:2 row_mask:0xf bank_mask:0x3
    v_and_b32_dpp v19, v8, v7 row_newbcast:2 row_mask:0xf bank_mask:0x3
    v_and_b32_dpp v16, v8, v4 row_newbcast:3 row_mask:0xf bank_mask:0xc
    v_and_b32_dpp v17, v8, v5 row_newbcast:3 row_mask:0xf bank_mask:0xc
    v_and_b32_dpp v18, v8, v6 row_newbcast:3 row_mask:0xf bank_mask:0xc
    v_and_b32_dpp v19, v8, v7 row_newbcast:3 row_mask:0xf bank_mask:0xc
    s_nop 1
    v_mfma_f32_16x16x32_bf16 v[20:23], v[16:19], v[140:143], v[20:23]
    v_and_b32_dpp v16, v8, v4 row_newbcast:10 row_mask:0xf bank_mask:0x3
    v_and_b32_dpp v17, v8, v5 row_newbcast:10 row_mask:0xf bank_mask:0x3
    v_and_b32_dpp v18, v8, v6 row_newbcast:10 row_mask:0xf bank_mask:0x3
    v_and_b32_dpp v19, v8, v7 row_newbcast:10 row_mask:0xf bank_mask:0x3
    v_and_b32_dpp v16, v8, v4 row_newbcast:11 row_mask:0xf bank_mask:0xc
    v_and_b32_dpp v17, v8, v5 row_newbcast:11 row_mask:0xf bank_mask:0xc
    v_and_b32_dpp v18, v8, v6 row_newbcast:11 row_mask:0xf bank_mask:0xc
    v_and_b32_dpp v19, v8, v7 row_newbcast:11 row_mask:0xf bank_mask:0xc
    s_nop 1
    v_mfma_f32_16x16x32_bf16 v[24:27], v[16:19], v[140:143], v[24:27]
    v_and_b32_dpp v16, v9, v4 row_newbcast:2 row_mask:0xf bank_mask:0x3
    v_and_b32_dpp v17, v9, v5 row_newbcast:2 row_mask:0xf bank_mask:0x3
    v_and_b32_dpp v18, v9, v6 row_newbcast:2 row_mask:0xf bank_mask:0x3
    v_and_b32_dpp v19, v9, v7 row_newbcast:2 row_mask:0xf bank_mask:0x3
    v_and_b32_dpp v16, v9, v4 row_newbcast:3 row_mask:0xf bank_mask:0xc
    v_and_b32_dpp v17, v9, v5 row_newbcast:3 row_mask:0xf bank_mask:0xc
    v_and_b32_dpp v18, v9, v6 row_newbcast:3 row_mask:0xf bank_mask:0xc
    v_and_b32_dpp v19, v9, v7 row_newbcast:3 row_mask:0xf bank_mask:0xc
    s_nop 1
    v_mfma_f32_16x16x32_bf16 v[28:31], v[16:19], v[140:143], v[28:31]
    v_and_b32_dpp v16, v9, v4 row_newbcast:10 row_mask:0xf bank_mask:0x3
    v_and_b32_dpp v17, v9, v5 row_newbcast:10 row_mask:0xf bank_mask:0x3
    v_and_b32_dpp v18, v9, v6 row_newbcast:10 row_mask:0xf bank_mask:0x3
    v_and_b32_dpp v19, v9, v7 row_newbcast:10 row_mask:0xf bank_mask:0x3
    v_and_b32_dpp v16, v9, v4 row_newbcast:11 row_mask:0xf bank_mask:0xc
    v_and_b32_dpp v17, v9, v5 row_newbcast:11 row_mask:0xf bank_mask:0xc
    v_and_b32_dpp v18, v9, v6 row_newbcast:11 row_mask:0xf bank_mask:0xc
    v_and_b32_dpp v19, v9, v7 row_newbcast:11 row_mask:0xf bank_mask:0xc
    s_nop 1
    v_mfma_f32_16x16x32_bf16 v[32:35], v[16:19], v[140:143], v[32:35]
    v_and_b32_dpp v16, v8, v4 row_newbcast:4 row_mask:0xf bank_mask:0x3
    v_and_b32_dpp v17, v8, v5 row_newbcast:4 row_mask:0xf bank_mask:0x3
    v_and_b32_dpp v18, v8, v6 row_newbcast:4 row_mask:0xf bank_mask:0x3
    v_and_b32_dpp v19, v8, v7 row_newbcast:4 row_mask:0xf bank_mask:0x3
    v_and_b32_dpp v16, v8, v4 row_newbcast:5 row_mask:0xf bank_mask:0xc
    v_and_b32_dpp v17, v8, v5 row_newbcast:5 row_mask:0xf bank_mask:0xc
    v_and_b32_dpp v18, v8, v6 row_newbcast:5 row_mask:0xf bank_mask:0xc
    v_and_b32_dpp v19, v8, v7 row_newbcast:5 row_mask:0xf bank_mask:0xc
    s_nop 1
    v_mfma_f32_16x16x32_bf16 v[20:23], v[16:19], v[144:147], v[20:23]
    v_and_b32_dpp v16, v8, v4 row_newbcast:12 row_mask:0xf bank_mask:0x3
    v_and_b32_dpp v17, v8, v5 row_newbcast:12 row_mask:0xf bank_mask:0x3
    v_and_b32_dpp v18, v8, v6 row_newbcast:12 row_mask:0xf bank_mask:0x3
    v_and_b32_dpp v19, v8, v7 row_newbcast:12 row_mask:0xf bank_mask:0x3
    v_and_b32_dpp v16, v8, v4 row_newbcast:13 row_mask:0xf bank_mask:0xc
    v_and_b32_dpp v17, v8, v5 row_newbcast:13 row_mask:0xf bank_mask:0xc
    v_and_b32_dpp v18, v8, v6 row_newbcast:13 row_mask:0xf bank_mask:0xc
    v_and_b32_dpp v19, v8, v7 row_newbcast:13 row_mask:0xf bank_mask:0xc
    s_nop 1
    v_mfma_f32_16x16x32_bf16 v[24:27], v[16:19], v[144:147], v[24:27]
    v_and_b32_dpp v16, v9, v4 row_newbcast:4 row_mask:0xf bank_mask:0x3
    v_and_b32_dpp v17, v9, v5 row_newbcast:4 row_mask:0xf bank_mask:0x3
    v_and_b32_dpp v18, v9, v6 row_newbcast:4 row_mask:0xf bank_mask:0x3
    v_and_b32_dpp v19, v9, v7 row_newbcast:4 row_mask:0xf bank_mask:0x3
    v_and_b32_dpp v16, v9, v4 row_newbcast:5 row_mask:0xf bank_mask:0xc
    v_and_b32_dpp v17, v9, v5 row_newbcast:5 row_mask:0xf bank_mask:0xc
    v_and_b32_dpp v18, v9, v6 row_newbcast:5 row_mask:0xf bank_mask:0xc
    v_and_b32_dpp v19, v9, v7 row_newbcast:5 row_mask:0xf bank_mask:0xc
    s_nop 1
    v_mfma_f32_16x16x32_bf16 v[28:31], v[16:19], v[144:147], v[28:31]
    v_and_b32_dpp v16, v9, v4 row_newbcast:12 row_mask:0xf bank_mask:0x3
    v_and_b32_dpp v17, v9, v5 row_newbcast:12 row_mask:0xf bank_mask:0x3
    v_and_b32_dpp v18, v9, v6 row_newbcast:12 row_mask:0xf bank_mask:0x3
    v_and_b32_dpp v19, v9, v7 row_newbcast:12 row_mask:0xf bank_mask:0x3
    v_and_b32_dpp v16, v9, v4 row_newbcast:13 row_mask:0xf bank_mask:0xc
    v_and_b32_dpp v17, v9, v5 row_newbcast:13 row_mask:0xf bank_mask:0xc
    v_and_b32_dpp v18, v9, v6 row_newbcast:13 row_mask:0xf bank_mask:0xc
    v_and_b32_dpp v19, v9, v7 row_newbcast:13 row_mask:0xf bank_mask:0xc
    s_nop 1
    v_mfma_f32_16x16x32_bf16 v[32:35], v[16:19], v[144:147], v[32:35]
    v_and_b32_dpp v16, v8, v4 row_newbcast:6 row_mask:0xf bank_mask:0x3
    v_and_b32_dpp v17, v8, v5 row_newbcast:6 row_mask:0xf bank_mask:0x3
    v_and_b32_dpp v18, v8, v6 row_newbcast:6 row_mask:0xf bank_mask:0x3
    v_and_b32_dpp v19, v8, v7 row_newbcast:6 row_mask:0xf bank_mask:0x3
    v_and_b32_dpp v16, v8, v4 row_newbcast:7 row_mask:0xf bank_mask:0xc
    v_and_b32_dpp v17, v8, v5 row_newbcast:7 row_mask:0xf bank_mask:0xc
    v_and_b32_dpp v18, v8, v6 row_newbcast:7 row_mask:0xf bank_mask:0xc
    v_and_b32_dpp v19, v8, v7 row_newbcast:7 row_mask:0xf bank_mask:0xc
    s_nop 1
    v_mfma_f32_16x16x32_bf16 v[20:23], v[16:19], v[148:151], v[20:23]
    v_and_b32_dpp v16, v8, v4 row_newbcast:14 row_mask:0xf bank_mask:0x3
    v_and_b32_dpp v17, v8, v5 row_newbcast:14 row_mask:0xf bank_mask:0x3
    v_and_b32_dpp v18, v8, v6 row_newbcast:14 row_mask:0xf bank_mask:0x3
    v_and_b32_dpp v19, v8, v7 row_newbcast:14 row_mask:0xf bank_mask:0x3
    v_and_b32_dpp v16, v8, v4 row_newbcast:15 row_mask:0xf bank_mask:0xc
    v_and_b32_dpp v17, v8, v5 row_newbcast:15 row_mask:0xf bank_mask:0xc
    v_and_b32_dpp v18, v8, v6 row_newbcast:15 row_mask:0xf bank_mask:0xc
    v_and_b32_dpp v19, v8, v7 row_newbcast:15 row_mask:0xf bank_mask:0xc
    s_nop 1
    v_mfma_f32_16x16x32_bf16 v[24:27], v[16:19], v[148:151], v[24:27]
    v_and_b32_dpp v16, v9, v4 row_newbcast:6 row_mask:0xf bank_mask:0x3
    v_and_b32_dpp v17, v9, v5 row_newbcast:6 row_mask:0xf bank_mask:0x3
    v_and_b32_dpp v18, v9, v6 row_newbcast:6 row_mask:0xf bank_mask:0x3
    v_and_b32_dpp v19, v9, v7 row_newbcast:6 row_mask:0xf bank_mask:0x3
    v_and_b32_dpp v16, v9, v4 row_newbcast:7 row_mask:0xf bank_mask:0xc
    v_and_b32_dpp v17, v9, v5 row_newbcast:7 row_mask:0xf bank_mask:0xc
    v_and_b32_dpp v18, v9, v6 row_newbcast:7 row_mask:0xf bank_mask:0xc
    v_and_b32_dpp v19, v9, v7 row_newbcast:7 row_mask:0xf bank_mask:0xc
    s_nop 1
    v_mfma_f32_16x16x32_bf16 v[28:31], v[16:19], v[148:151], v[28:31]
    v_and_b32_dpp v16, v9, v4 row_newbcast:14 row_mask:0xf bank_mask:0x3
    v_and_b32_dpp v17, v9, v5 row_newbcast:14 row_mask:0xf bank_mask:0x3
    v_and_b32_dpp v18, v9, v6 row_newbcast:14 row_mask:0xf bank_mask:0x3
    v_and_b32_dpp v19, v9, v7 row_newbcast:14 row_mask:0xf bank_mask:0x3
    v_and_b32_dpp v16, v9, v4 row_newbcast:15 row_mask:0xf bank_mask:0xc
    v_and_b32_dpp v17, v9, v5 row_newbcast:15 row_mask:0xf bank_mask:0xc
    v_and_b32_dpp v18, v9, v6 row_newbcast:15 row_mask:0xf bank_mask:0xc
    v_and_b32_dpp v19, v9, v7 row_newbcast:15 row_mask:0xf bank_mask:0xc
    s_nop 1
    v_mfma_f32_16x16x32_bf16 v[32:35], v[16:19], v[148:151], v[32:35]
    v_perm_b32 v8, v42, v42, s64
    v_perm_b32 v9, v42, v42, s65
    s_nop 1
    v_and_b32_dpp v16, v8, v4 row_newbcast:0 row_mask:0xf bank_mask:0x3
    v_and_b32_dpp v17, v8, v5 row_newbcast:0 row_mask:0xf bank_mask:0x3
    v_and_b32_dpp v18, v8, v6 row_newbcast:0 row_mask:0xf bank_mask:0x3
    v_and_b32_dpp v19, v8, v7 row_newbcast:0 row_mask:0xf bank_mask:0x3
    v_and_b32_dpp v16, v8, v4 row_newbcast:1 row_mask:0xf bank_mask:0xc
    v_and_b32_dpp v17, v8, v5 row_newbcast:1 row_mask:0xf bank_mask:0xc
    v_and_b32_dpp v18, v8, v6 row_newbcast:1 row_mask:0xf bank_mask:0xc
    v_and_b32_dpp v19, v8, v7 row_newbcast:1 row_mask:0xf bank_mask:0xc
    s_nop 1
    v_mfma_f32_16x16x32_bf16 v[20:23], v[16:19], v[152:155], v[20:23]
    v_and_b32_dpp v16, v8, v4 row_newbcast:8 row_mask:0xf bank_mask:0x3
    v_and_b32_dpp v17, v8, v5 row_newbcast:8 row_mask:0xf bank_mask:0x3
    v_and_b32_dpp v18, v8, v6 row_newbcast:8 row_mask:0xf bank_mask:0x3
    v_and_b32_dpp v19, v8, v7 row_newbcast:8 row_mask:0xf bank_mask:0x3
    v_and_b32_dpp v16, v8, v4 row_newbcast:9 row_mask:0xf bank_mask:0xc
    v_and_b32_dpp v17, v8, v5 row_newbcast:9 row_mask:0xf bank_mask:0xc
    v_and_b32_dpp v18, v8, v6 row_newbcast:9 row_mask:0xf bank_mask:0xc
    v_and_b32_dpp v19, v8, v7 row_newbcast:9 row_mask:0xf bank_mask:0xc
    s_nop 1
    v_mfma_f32_16x16x32_bf16 v[24:27], v[16:19], v[152:155], v[24:27]
    v_and_b32_dpp v16, v9, v4 row_newbcast:0 row_mask:0xf bank_mask:0x3
    v_and_b32_dpp v17, v9, v5 row_newbcast:0 row_mask:0xf bank_mask:0x3
    v_and_b32_dpp v18, v9, v6 row_newbcast:0 row_mask:0xf bank_mask:0x3
    v_and_b32_dpp v19, v9, v7 row_newbcast:0 row_mask:0xf bank_mask:0x3
    v_and_b32_dpp v16, v9, v4 row_newbcast:1 row_mask:0xf bank_mask:0xc
    v_and_b32_dpp v17, v9, v5 row_newbcast:1 row_mask:0xf bank_mask:0xc
    v_and_b32_dpp v18, v9, v6 row_newbcast:1 row_mask:0xf bank_mask:0xc
    v_and_b32_dpp v19, v9, v7 row_newbcast:1 row_mask:0xf bank_mask:0xc
    s_nop 1
    v_mfma_f32_16x16x32_bf16 v[28:31], v[16:19], v[152:155], v[28:31]
    v_and_b32_dpp v16, v9, v4 row_newbcast:8 row_mask:0xf bank_mask:0x3
    v_and_b32_dpp v17, v9, v5 row_newbcast:8 row_mask:0xf bank_mask:0x3
    v_and_b32_dpp v18, v9, v6 row_newbcast:8 row_mask:0xf bank_mask:0x3
    v_and_b32_dpp v19, v9, v7 row_newbcast:8 row_mask:0xf bank_mask:0x3
    v_and_b32_dpp v16, v9, v4 row_newbcast:9 row_mask:0xf bank_mask:0xc
    v_and_b32_dpp v17, v9, v5 row_newbcast:9 row_mask:0xf bank_mask:0xc
    v_and_b32_dpp v18, v9, v6 row_newbcast:9 row_mask:0xf bank_mask:0xc
    v_and_b32_dpp v19, v9, v7 row_newbcast:9 row_mask:0xf bank_mask:0xc
    s_nop 1
    v_mfma_f32_16x16x32_bf16 v[32:35], v[16:19], v[152:155], v[32:35]
    v_and_b32_dpp v16, v8, v4 row_newbcast:2 row_mask:0xf bank_mask:0x3
    v_and_b32_dpp v17, v8, v5 row_newbcast:2 row_mask:0xf bank_mask:0x3
    v_and_b32_dpp v18, v8, v6 row_newbcast:2 row_mask:0xf bank_mask:0x3
    v_and_b32_dpp v19, v8, v7 row_newbcast:2 row_mask:0xf bank_mask:0x3
    v_and_b32_dpp v16, v8, v4 row_newbcast:3 row_mask:0xf bank_mask:0xc
    v_and_b32_dpp v17, v8, v5 row_newbcast:3 row_mask:0xf bank_mask:0xc
    v_and_b32_dpp v18, v8, v6 row_newbcast:3 row_mask:0xf bank_mask:0xc
    v_and_b32_dpp v19, v8, v7 row_newbcast:3 row_mask:0xf bank_mask:0xc
    s_nop 1
    v_mfma_f32_16x16x32_bf16 v[20:23], v[16:19], v[156:159], v[20:23]
    v_and_b32_dpp v16, v8, v4 row_newbcast:10 row_mask:0xf bank_mask:0x3
    v_and_b32_dpp v17, v8, v5 row_newbcast:10 row_mask:0xf bank_mask:0x3
    v_and_b32_dpp v18, v8, v6 row_newbcast:10 row_mask:0xf bank_mask:0x3
    v_and_b32_dpp v19, v8, v7 row_newbcast:10 row_mask:0xf bank_mask:0x3
    v_and_b32_dpp v16, v8, v4 row_newbcast:11 row_mask:0xf bank_mask:0xc
    v_and_b32_dpp v17, v8, v5 row_newbcast:11 row_mask:0xf bank_mask:0xc
    v_and_b32_dpp v18, v8, v6 row_newbcast:11 row_mask:0xf bank_mask:0xc
    v_and_b32_dpp v19, v8, v7 row_newbcast:11 row_mask:0xf bank_mask:0xc
    s_nop 1
    v_mfma_f32_16x16x32_bf16 v[24:27], v[16:19], v[156:159], v[24:27]
    v_and_b32_dpp v16, v9, v4 row_newbcast:2 row_mask:0xf bank_mask:0x3
    v_and_b32_dpp v17, v9, v5 row_newbcast:2 row_mask:0xf bank_mask:0x3
    v_and_b32_dpp v18, v9, v6 row_newbcast:2 row_mask:0xf bank_mask:0x3
    v_and_b32_dpp v19, v9, v7 row_newbcast:2 row_mask:0xf bank_mask:0x3
    v_and_b32_dpp v16, v9, v4 row_newbcast:3 row_mask:0xf bank_mask:0xc
    v_and_b32_dpp v17, v9, v5 row_newbcast:3 row_mask:0xf bank_mask:0xc
    v_and_b32_dpp v18, v9, v6 row_newbcast:3 row_mask:0xf bank_mask:0xc
    v_and_b32_dpp v19, v9, v7 row_newbcast:3 row_mask:0xf bank_mask:0xc
    s_nop 1
    v_mfma_f32_16x16x32_bf16 v[28:31], v[16:19], v[156:159], v[28:31]
    v_and_b32_dpp v16, v9, v4 row_newbcast:10 row_mask:0xf bank_mask:0x3
    v_and_b32_dpp v17, v9, v5 row_newbcast:10 row_mask:0xf bank_mask:0x3
    v_and_b32_dpp v18, v9, v6 row_newbcast:10 row_mask:0xf bank_mask:0x3
    v_and_b32_dpp v19, v9, v7 row_newbcast:10 row_mask:0xf bank_mask:0x3
    v_and_b32_dpp v16, v9, v4 row_newbcast:11 row_mask:0xf bank_mask:0xc
    v_and_b32_dpp v17, v9, v5 row_newbcast:11 row_mask:0xf bank_mask:0xc
    v_and_b32_dpp v18, v9, v6 row_newbcast:11 row_mask:0xf bank_mask:0xc
    v_and_b32_dpp v19, v9, v7 row_newbcast:11 row_mask:0xf bank_mask:0xc
    s_nop 1
    v_mfma_f32_16x16x32_bf16 v[32:35], v[16:19], v[156:159], v[32:35]
    v_and_b32_dpp v16, v8, v4 row_newbcast:4 row_mask:0xf bank_mask:0x3
    v_and_b32_dpp v17, v8, v5 row_newbcast:4 row_mask:0xf bank_mask:0x3
    v_and_b32_dpp v18, v8, v6 row_newbcast:4 row_mask:0xf bank_mask:0x3
    v_and_b32_dpp v19, v8, v7 row_newbcast:4 row_mask:0xf bank_mask:0x3
    v_and_b32_dpp v16, v8, v4 row_newbcast:5 row_mask:0xf bank_mask:0xc
    v_and_b32_dpp v17, v8, v5 row_newbcast:5 row_mask:0xf bank_mask:0xc
    v_and_b32_dpp v18, v8, v6 row_newbcast:5 row_mask:0xf bank_mask:0xc
    v_and_b32_dpp v19, v8, v7 row_newbcast:5 row_mask:0xf bank_mask:0xc
    s_nop 1
    v_mfma_f32_16x16x32_bf16 v[20:23], v[16:19], v[160:163], v[20:23]
    v_and_b32_dpp v16, v8, v4 row_newbcast:12 row_mask:0xf bank_mask:0x3
    v_and_b32_dpp v17, v8, v5 row_newbcast:12 row_mask:0xf bank_mask:0x3
    v_and_b32_dpp v18, v8, v6 row_newbcast:12 row_mask:0xf bank_mask:0x3
    v_and_b32_dpp v19, v8, v7 row_newbcast:12 row_mask:0xf bank_mask:0x3
    v_and_b32_dpp v16, v8, v4 row_newbcast:13 row_mask:0xf bank_mask:0xc
    v_and_b32_dpp v17, v8, v5 row_newbcast:13 row_mask:0xf bank_mask:0xc
    v_and_b32_dpp v18, v8, v6 row_newbcast:13 row_mask:0xf bank_mask:0xc
    v_and_b32_dpp v19, v8, v7 row_newbcast:13 row_mask:0xf bank_mask:0xc
    s_nop 1
    v_mfma_f32_16x16x32_bf16 v[24:27], v[16:19], v[160:163], v[24:27]
    v_and_b32_dpp v16, v9, v4 row_newbcast:4 row_mask:0xf bank_mask:0x3
    v_and_b32_dpp v17, v9, v5 row_newbcast:4 row_mask:0xf bank_mask:0x3
    v_and_b32_dpp v18, v9, v6 row_newbcast:4 row_mask:0xf bank_mask:0x3
    v_and_b32_dpp v19, v9, v7 row_newbcast:4 row_mask:0xf bank_mask:0x3
    v_and_b32_dpp v16, v9, v4 row_newbcast:5 row_mask:0xf bank_mask:0xc
    v_and_b32_dpp v17, v9, v5 row_newbcast:5 row_mask:0xf bank_mask:0xc
    v_and_b32_dpp v18, v9, v6 row_newbcast:5 row_mask:0xf bank_mask:0xc
    v_and_b32_dpp v19, v9, v7 row_newbcast:5 row_mask:0xf bank_mask:0xc
    s_nop 1
    v_mfma_f32_16x16x32_bf16 v[28:31], v[16:19], v[160:163], v[28:31]
    v_and_b32_dpp v16, v9, v4 row_newbcast:12 row_mask:0xf bank_mask:0x3
    v_and_b32_dpp v17, v9, v5 row_newbcast:12 row_mask:0xf bank_mask:0x3
    v_and_b32_dpp v18, v9, v6 row_newbcast:12 row_mask:0xf bank_mask:0x3
    v_and_b32_dpp v19, v9, v7 row_newbcast:12 row_mask:0xf bank_mask:0x3
    v_and_b32_dpp v16, v9, v4 row_newbcast:13 row_mask:0xf bank_mask:0xc
    v_and_b32_dpp v17, v9, v5 row_newbcast:13 row_mask:0xf bank_mask:0xc
    v_and_b32_dpp v18, v9, v6 row_newbcast:13 row_mask:0xf bank_mask:0xc
    v_and_b32_dpp v19, v9, v7 row_newbcast:13 row_mask:0xf bank_mask:0xc
    s_nop 1
    v_mfma_f32_16x16x32_bf16 v[32:35], v[16:19], v[160:163], v[32:35]
    v_and_b32_dpp v16, v8, v4 row_newbcast:6 row_mask:0xf bank_mask:0x3
    v_and_b32_dpp v17, v8, v5 row_newbcast:6 row_mask:0xf bank_mask:0x3
    v_and_b32_dpp v18, v8, v6 row_newbcast:6 row_mask:0xf bank_mask:0x3
    v_and_b32_dpp v19, v8, v7 row_newbcast:6 row_mask:0xf bank_mask:0x3
    v_and_b32_dpp v16, v8, v4 row_newbcast:7 row_mask:0xf bank_mask:0xc
    v_and_b32_dpp v17, v8, v5 row_newbcast:7 row_mask:0xf bank_mask:0xc
    v_and_b32_dpp v18, v8, v6 row_newbcast:7 row_mask:0xf bank_mask:0xc
    v_and_b32_dpp v19, v8, v7 row_newbcast:7 row_mask:0xf bank_mask:0xc
    s_nop 1
    v_mfma_f32_16x16x32_bf16 v[20:23], v[16:19], v[164:167], v[20:23]
    v_and_b32_dpp v16, v8, v4 row_newbcast:14 row_mask:0xf bank_mask:0x3
    v_and_b32_dpp v17, v8, v5 row_newbcast:14 row_mask:0xf bank_mask:0x3
    v_and_b32_dpp v18, v8, v6 row_newbcast:14 row_mask:0xf bank_mask:0x3
    v_and_b32_dpp v19, v8, v7 row_newbcast:14 row_mask:0xf bank_mask:0x3
    v_and_b32_dpp v16, v8, v4 row_newbcast:15 row_mask:0xf bank_mask:0xc
    v_and_b32_dpp v17, v8, v5 row_newbcast:15 row_mask:0xf bank_mask:0xc
    v_and_b32_dpp v18, v8, v6 row_newbcast:15 row_mask:0xf bank_mask:0xc
    v_and_b32_dpp v19, v8, v7 row_newbcast:15 row_mask:0xf bank_mask:0xc
    s_nop 1
    v_mfma_f32_16x16x32_bf16 v[24:27], v[16:19], v[164:167], v[24:27]
    v_and_b32_dpp v16, v9, v4 row_newbcast:6 row_mask:0xf bank_mask:0x3
    v_and_b32_dpp v17, v9, v5 row_newbcast:6 row_mask:0xf bank_mask:0x3
    v_and_b32_dpp v18, v9, v6 row_newbcast:6 row_mask:0xf bank_mask:0x3
    v_and_b32_dpp v19, v9, v7 row_newbcast:6 row_mask:0xf bank_mask:0x3
    v_and_b32_dpp v16, v9, v4 row_newbcast:7 row_mask:0xf bank_mask:0xc
    v_and_b32_dpp v17, v9, v5 row_newbcast:7 row_mask:0xf bank_mask:0xc
    v_and_b32_dpp v18, v9, v6 row_newbcast:7 row_mask:0xf bank_mask:0xc
    v_and_b32_dpp v19, v9, v7 row_newbcast:7 row_mask:0xf bank_mask:0xc
    s_nop 1
    v_mfma_f32_16x16x32_bf16 v[28:31], v[16:19], v[164:167], v[28:31]
    v_and_b32_dpp v16, v9, v4 row_newbcast:14 row_mask:0xf bank_mask:0x3
    v_and_b32_dpp v17, v9, v5 row_newbcast:14 row_mask:0xf bank_mask:0x3
    v_and_b32_dpp v18, v9, v6 row_newbcast:14 row_mask:0xf bank_mask:0x3
    v_and_b32_dpp v19, v9, v7 row_newbcast:14 row_mask:0xf bank_mask:0x3
    v_and_b32_dpp v16, v9, v4 row_newbcast:15 row_mask:0xf bank_mask:0xc
    v_and_b32_dpp v17, v9, v5 row_newbcast:15 row_mask:0xf bank_mask:0xc
    v_and_b32_dpp v18, v9, v6 row_newbcast:15 row_mask:0xf bank_mask:0xc
    v_and_b32_dpp v19, v9, v7 row_newbcast:15 row_mask:0xf bank_mask:0xc
    s_nop 1
    v_mfma_f32_16x16x32_bf16 v[32:35], v[16:19], v[164:167], v[32:35]
    s_mov_b32 s3, 1024
    v_mul_lo_u32 v48, v55, s3
    v_add_u32 v48, v48, v54
    s_nop 5
    s_mov_b64 exec, s[56:57]
    ds_write_b128 v48, v[20:23] offset:0
    ds_write_b128 v48, v[24:27] offset:256
    ds_write_b128 v48, v[28:31] offset:512
    ds_write_b128 v48, v[32:35] offset:768
    s_mov_b64 exec, -1
    s_waitcnt lgkmcnt(0)
    ds_read_b128 v[20:23], v14 offset:14336
    ds_read_b128 v[24:27], v14 offset:15360
    s_waitcnt lgkmcnt(0)
    v_add_f32 v20, v20, v24
    v_add_f32 v21, v21, v25
    v_add_f32 v22, v22, v26
    v_add_f32 v23, v23, v27
    v_min_u32 v20, -2, v20
    v_min_u32 v21, -2, v21
    v_min_u32 v22, -2, v22
    v_min_u32 v23, -2, v23
    buffer_store_dwordx4 v[20:23], v14, s[36:39], 0 offen sc0 sc1
    s_nop 1
L_ffn_done:
    s_sub_u32 s61, s15, 56
    s_min_u32 s60, s61, 7
    s_cmp_eq_u32 s31, 7
    s_cbranch_scc1 L_h7
    s_mul_i32 s3, s29, 229376
    s_lshl_b32 s63, s31, 7
    s_add_u32 s3, s3, s63
    s_add_u32 s32, s12, s3
    s_addc_u32 s33, s13, 0
    s_sub_u32 s34, 229376, s63
    s_movk_i32 s3, 7168
    v_mul_lo_u32 v4, v3, s3
    v_lshl_add_u32 v4, v2, 3, v4
    v_add_u32 v5, 3584, v4
    s_mov_b32 s48, 0
    s_mov_b32 s49, 28672
    s_mov_b32 s50, 57344
    s_mov_b32 s51, 86016
    s_mov_b32 s52, 114688
    s_mov_b32 s53, 143360
    s_mov_b32 s54, 172032
    s_mov_b32 s55, 200704
    s_mov_b32 s64, 0x05040100
    s_mov_b32 s65, 0x07060302
    buffer_load_dwordx2 v[40:41], v4, s[32:35], s48 offen offset:0
    s_waitcnt vmcnt(3)
    buffer_load_dwordx2 v[42:43], v4, s[32:35], s48 offen offset:896
    s_waitcnt vmcnt(3)
    buffer_load_dwordx2 v[44:45], v4, s[32:35], s48 offen offset:1792
    s_waitcnt vmcnt(3)
    buffer_load_dwordx2 v[46:47], v4, s[32:35], s48 offen offset:2688
    s_waitcnt vmcnt(3)
    buffer_load_dwordx2 v[48:49], v5, s[32:35], s48 offen offset:0
    s_waitcnt vmcnt(3)
    buffer_load_dwordx2 v[50:51], v5, s[32:35], s48 offen offset:896
    s_waitcnt vmcnt(3)
    buffer_load_dwordx2 v[52:53], v5, s[32:35], s48 offen offset:1792
    s_waitcnt vmcnt(3)
    buffer_load_dwordx2 v[54:55], v5, s[32:35], s48 offen offset:2688
    s_waitcnt vmcnt(3)
    buffer_load_dwordx2 v[56:57], v4, s[32:35], s49 offen offset:0
    s_waitcnt vmcnt(3)
    buffer_load_dwordx2 v[58:59], v4, s[32:35], s49 offen offset:896
    s_waitcnt vmcnt(3)
    buffer_load_dwordx2 v[60:61], v4, s[32:35], s49 offen offset:1792
    s_waitcnt vmcnt(3)
    buffer_load_dwordx2 v[62:63], v4, s[32:35], s49 offen offset:2688
    s_waitcnt vmcnt(3)
    buffer_load_dwordx2 v[64:65], v5, s[32:35], s49 offen offset:0
    s_waitcnt vmcnt(3)
    buffer_load_dwordx2 v[66:67], v5, s[32:35], s49 offen offset:896
    s_waitcnt vmcnt(3)
    buffer_load_dwordx2 v[68:69], v5, s[32:35], s49 offen offset:1792
    s_waitcnt vmcnt(3)
    buffer_load_dwordx2 v[70:71], v5, s[32:35], s49 offen offset:2688
    s_waitcnt vmcnt(3)
    buffer_load_dwordx2 v[72:73], v4, s[32:35], s50 offen offset:0
    s_waitcnt vmcnt(3)
    buffer_load_dwordx2 v[74:75], v4, s[32:35], s50 offen offset:896
    s_waitcnt vmcnt(3)
    buffer_load_dwordx2 v[76:77], v4, s[32:35], s50 offen offset:1792
    s_waitcnt vmcnt(3)
    buffer_load_dwordx2 v[78:79], v4, s[32:35], s50 offen offset:2688
    s_waitcnt vmcnt(3)
    buffer_load_dwordx2 v[80:81], v5, s[32:35], s50 offen offset:0
    s_waitcnt vmcnt(3)
    buffer_load_dwordx2 v[82:83], v5, s[32:35], s50 offen offset:896
    s_waitcnt vmcnt(3)
    buffer_load_dwordx2 v[84:85], v5, s[32:35], s50 offen offset:1792
    s_waitcnt vmcnt(3)
    buffer_load_dwordx2 v[86:87], v5, s[32:35], s50 offen offset:2688
    s_waitcnt vmcnt(3)
    buffer_load_dwordx2 v[88:89], v4, s[32:35], s51 offen offset:0
    s_waitcnt vmcnt(3)
    buffer_load_dwordx2 v[90:91], v4, s[32:35], s51 offen offset:896
    s_waitcnt vmcnt(3)
    buffer_load_dwordx2 v[92:93], v4, s[32:35], s51 offen offset:1792
    s_waitcnt vmcnt(3)
    buffer_load_dwordx2 v[94:95], v4, s[32:35], s51 offen offset:2688
    s_waitcnt vmcnt(3)
    buffer_load_dwordx2 v[96:97], v5, s[32:35], s51 offen offset:0
    s_waitcnt vmcnt(3)
    buffer_load_dwordx2 v[98:99], v5, s[32:35], s51 offen offset:896
    s_waitcnt vmcnt(3)
    buffer_load_dwordx2 v[100:101], v5, s[32:35], s51 offen offset:1792
    s_waitcnt vmcnt(3)
    buffer_load_dwordx2 v[102:103], v5, s[32:35], s51 offen offset:2688
    s_waitcnt vmcnt(3)
    buffer_load_dwordx2 v[104:105], v4, s[32:35], s52 offen offset:0
    s_waitcnt vmcnt(3)
    buffer_load_dwordx2 v[106:107], v4, s[32:35], s52 offen offset:896
    s_waitcnt vmcnt(3)
    buffer_load_dwordx2 v[108:109], v4, s[32:35], s52 offen offset:1792
    s_waitcnt vmcnt(3)
    buffer_load_dwordx2 v[110:111], v4, s[32:35], s52 offen offset:2688
    s_waitcnt vmcnt(3)
    buffer_load_dwordx2 v[112:113], v5, s[32:35], s52 offen offset:0
    s_waitcnt vmcnt(3)
    buffer_load_dwordx2 v[114:115], v5, s[32:35], s52 offen offset:896
    s_waitcnt vmcnt(3)
    buffer_load_dwordx2 v[116:117], v5, s[32:35], s52 offen offset:1792
    s_waitcnt vmcnt(3)
    buffer_load_dwordx2 v[118:119], v5, s[32:35], s52 offen offset:2688
    s_waitcnt vmcnt(3)
    buffer_load_dwordx2 v[120:121], v4, s[32:35], s53 offen offset:0
    s_waitcnt vmcnt(3)
    buffer_load_dwordx2 v[122:123], v4, s[32:35], s53 offen offset:896
    s_waitcnt vmcnt(3)
    buffer_load_dwordx2 v[124:125], v4, s[32:35], s53 offen offset:1792
    s_waitcnt vmcnt(3)
    buffer_load_dwordx2 v[126:127], v4, s[32:35], s53 offen offset:2688
    s_waitcnt vmcnt(3)
    buffer_load_dwordx2 v[128:129], v5, s[32:35], s53 offen offset:0
    s_waitcnt vmcnt(3)
    buffer_load_dwordx2 v[130:131], v5, s[32:35], s53 offen offset:896
    s_waitcnt vmcnt(3)
    buffer_load_dwordx2 v[132:133], v5, s[32:35], s53 offen offset:1792
    s_waitcnt vmcnt(3)
    buffer_load_dwordx2 v[134:135], v5, s[32:35], s53 offen offset:2688
    s_waitcnt vmcnt(3)
    buffer_load_dwordx2 v[136:137], v4, s[32:35], s54 offen offset:0
    s_waitcnt vmcnt(3)
    buffer_load_dwordx2 v[138:139], v4, s[32:35], s54 offen offset:896
    s_waitcnt vmcnt(3)
    buffer_load_dwordx2 v[140:141], v4, s[32:35], s54 offen offset:1792
    s_waitcnt vmcnt(3)
    buffer_load_dwordx2 v[142:143], v4, s[32:35], s54 offen offset:2688
    s_waitcnt vmcnt(3)
    buffer_load_dwordx2 v[144:145], v5, s[32:35], s54 offen offset:0
    s_waitcnt vmcnt(3)
    buffer_load_dwordx2 v[146:147], v5, s[32:35], s54 offen offset:896
    s_waitcnt vmcnt(3)
    buffer_load_dwordx2 v[148:149], v5, s[32:35], s54 offen offset:1792
    s_waitcnt vmcnt(3)
    buffer_load_dwordx2 v[150:151], v5, s[32:35], s54 offen offset:2688
    s_waitcnt vmcnt(3)
    buffer_load_dwordx2 v[152:153], v4, s[32:35], s55 offen offset:0
    s_waitcnt vmcnt(3)
    buffer_load_dwordx2 v[154:155], v4, s[32:35], s55 offen offset:896
    s_waitcnt vmcnt(3)
    buffer_load_dwordx2 v[156:157], v4, s[32:35], s55 offen offset:1792
    s_waitcnt vmcnt(3)
    buffer_load_dwordx2 v[158:159], v4, s[32:35], s55 offen offset:2688
    s_waitcnt vmcnt(3)
    buffer_load_dwordx2 v[160:161], v5, s[32:35], s55 offen offset:0
    s_waitcnt vmcnt(3)
    buffer_load_dwordx2 v[162:163], v5, s[32:35], s55 offen offset:896
    s_waitcnt vmcnt(3)
    buffer_load_dwordx2 v[164:165], v5, s[32:35], s55 offen offset:1792
    s_waitcnt vmcnt(3)
    buffer_load_dwordx2 v[166:167], v5, s[32:35], s55 offen offset:2688
    s_waitcnt vmcnt(3)
    s_waitcnt vmcnt(0)
    v_perm_b32 v24, v42, v40, s64
    v_perm_b32 v25, v46, v44, s64
    v_perm_b32 v26, v50, v48, s64
    v_perm_b32 v27, v54, v52, s64
    v_perm_b32 v28, v42, v40, s65
    v_perm_b32 v29, v46, v44, s65
    v_perm_b32 v30, v50, v48, s65
    v_perm_b32 v31, v54, v52, s65
    v_perm_b32 v32, v43, v41, s64
    v_perm_b32 v33, v47, v45, s64
    v_perm_b32 v34, v51, v49, s64
    v_perm_b32 v35, v55, v53, s64
    v_perm_b32 v36, v43, v41, s65
    v_perm_b32 v37, v47, v45, s65
    v_perm_b32 v38, v51, v49, s65
    v_perm_b32 v39, v55, v53, s65
    v_perm_b32 v40, v58, v56, s64
    v_perm_b32 v41, v62, v60, s64
    v_perm_b32 v42, v66, v64, s64
    v_perm_b32 v43, v70, v68, s64
    v_perm_b32 v44, v58, v56, s65
    v_perm_b32 v45, v62, v60, s65
    v_perm_b32 v46, v66, v64, s65
    v_perm_b32 v47, v70, v68, s65
    v_perm_b32 v48, v59, v57, s64
    v_perm_b32 v49, v63, v61, s64
    v_perm_b32 v50, v67, v65, s64
    v_perm_b32 v51, v71, v69, s64
    v_perm_b32 v52, v59, v57, s65
    v_perm_b32 v53, v63, v61, s65
    v_perm_b32 v54, v67, v65, s65
    v_perm_b32 v55, v71, v69, s65
    v_perm_b32 v56, v74, v72, s64
    v_perm_b32 v57, v78, v76, s64
    v_perm_b32 v58, v82, v80, s64
    v_perm_b32 v59, v86, v84, s64
    v_perm_b32 v60, v74, v72, s65
    v_perm_b32 v61, v78, v76, s65
    v_perm_b32 v62, v82, v80, s65
    v_perm_b32 v63, v86, v84, s65
    v_perm_b32 v64, v75, v73, s64
    v_perm_b32 v65, v79, v77, s64
    v_perm_b32 v66, v83, v81, s64
    v_perm_b32 v67, v87, v85, s64
    v_perm_b32 v68, v75, v73, s65
    v_perm_b32 v69, v79, v77, s65
    v_perm_b32 v70, v83, v81, s65
    v_perm_b32 v71, v87, v85, s65
    v_perm_b32 v72, v90, v88, s64
    v_perm_b32 v73, v94, v92, s64
    v_perm_b32 v74, v98, v96, s64
    v_perm_b32 v75, v102, v100, s64
    v_perm_b32 v76, v90, v88, s65
    v_perm_b32 v77, v94, v92, s65
    v_perm_b32 v78, v98, v96, s65
    v_perm_b32 v79, v102, v100, s65
    v_perm_b32 v80, v91, v89, s64
    v_perm_b32 v81, v95, v93, s64
    v_perm_b32 v82, v99, v97, s64
    v_perm_b32 v83, v103, v101, s64
    v_perm_b32 v84, v91, v89, s65
    v_perm_b32 v85, v95, v93, s65
    v_perm_b32 v86, v99, v97, s65
    v_perm_b32 v87, v103, v101, s65
    v_perm_b32 v88, v106, v104, s64
    v_perm_b32 v89, v110, v108, s64
    v_perm_b32 v90, v114, v112, s64
    v_perm_b32 v91, v118, v116, s64
    v_perm_b32 v92, v106, v104, s65
    v_perm_b32 v93, v110, v108, s65
    v_perm_b32 v94, v114, v112, s65
    v_perm_b32 v95, v118, v116, s65
    v_perm_b32 v96, v107, v105, s64
    v_perm_b32 v97, v111, v109, s64
    v_perm_b32 v98, v115, v113, s64
    v_perm_b32 v99, v119, v117, s64
    v_perm_b32 v100, v107, v105, s65
    v_perm_b32 v101, v111, v109, s65
    v_perm_b32 v102, v115, v113, s65
    v_perm_b32 v103, v119, v117, s65
    v_perm_b32 v104, v122, v120, s64
    v_perm_b32 v105, v126, v124, s64
    v_perm_b32 v106, v130, v128, s64
    v_perm_b32 v107, v134, v132, s64
    v_perm_b32 v108, v122, v120, s65
    v_perm_b32 v109, v126, v124, s65
    v_perm_b32 v110, v130, v128, s65
    v_perm_b32 v111, v134, v132, s65
    v_perm_b32 v112, v123, v121, s64
    v_perm_b32 v113, v127, v125, s64
    v_perm_b32 v114, v131, v129, s64
    v_perm_b32 v115, v135, v133, s64
    v_perm_b32 v116, v123, v121, s65
    v_perm_b32 v117, v127, v125, s65
    v_perm_b32 v118, v131, v129, s65
    v_perm_b32 v119, v135, v133, s65
    v_perm_b32 v120, v138, v136, s64
    v_perm_b32 v121, v142, v140, s64
    v_perm_b32 v122, v146, v144, s64
    v_perm_b32 v123, v150, v148, s64
    v_perm_b32 v124, v138, v136, s65
    v_perm_b32 v125, v142, v140, s65
    v_perm_b32 v126, v146, v144, s65
    v_perm_b32 v127, v150, v148, s65
    v_perm_b32 v128, v139, v137, s64
    v_perm_b32 v129, v143, v141, s64
    v_perm_b32 v130, v147, v145, s64
    v_perm_b32 v131, v151, v149, s64
    v_perm_b32 v132, v139, v137, s65
    v_perm_b32 v133, v143, v141, s65
    v_perm_b32 v134, v147, v145, s65
    v_perm_b32 v135, v151, v149, s65
    v_perm_b32 v136, v154, v152, s64
    v_perm_b32 v137, v158, v156, s64
    v_perm_b32 v138, v162, v160, s64
    v_perm_b32 v139, v166, v164, s64
    v_perm_b32 v140, v154, v152, s65
    v_perm_b32 v141, v158, v156, s65
    v_perm_b32 v142, v162, v160, s65
    v_perm_b32 v143, v166, v164, s65
    v_perm_b32 v144, v155, v153, s64
    v_perm_b32 v145, v159, v157, s64
    v_perm_b32 v146, v163, v161, s64
    v_perm_b32 v147, v167, v165, s64
    v_perm_b32 v148, v155, v153, s65
    v_perm_b32 v149, v159, v157, s65
    v_perm_b32 v150, v163, v161, s65
    v_perm_b32 v151, v167, v165, s65
    s_branch L_h_w
L_h7:
    v_mov_b32 v48, 25664
HB_25:
    s_sleep 8
    ds_read_b32 v49, v48 offset:4
    s_waitcnt lgkmcnt(0)
    v_readfirstlane_b32 s3, v49
    s_cmp_lt_u32 s3, 4
    s_cbranch_scc1 HB_25
    v_mov_b32 v48, 25600
    ds_read_b128 v[20:23], v48
    ds_read_b128 v[24:27], v48 offset:16
    s_waitcnt lgkmcnt(0)
    v_max_f32 v50, v20, v22
    v_max3_f32 v50, v50, v24, v26
    v_sub_f32 v20, v20, v50
    v_sub_f32 v22, v22, v50
    v_sub_f32 v24, v24, v50
    v_sub_f32 v26, v26, v50
    v_exp_f32 v20, v20
    v_exp_f32 v22, v22
    v_exp_f32 v24, v24
    v_exp_f32 v26, v26
    s_nop 0
    v_mul_f32 v51, v20, v21
    v_fmac_f32 v51, v22, v23
    v_fmac_f32 v51, v24, v25
    v_fmac_f32 v51, v26, v27
    v_min_u32 v50, -2, v50
    v_min_u32 v51, -2, v51
    s_lshl_b32 s3, s30, 7
    v_lshl_add_u32 v48, v2, 3, s3
    s_mov_b64 exec, 0xff
    buffer_store_dwordx2 v[50:51], v48, s[40:43], 0 offen offset:1280 sc0 sc1
    s_mov_b64 exec, -1
    s_cmp_ge_u32 s61, 7
    s_cbranch_scc1 L_h_w
    s_mov_b32 s64, s24
    s_mov_b32 s65, s25
    s_mov_b32 s66, 256
    v_lshrrev_b32 v48, 2, v14
    s_mov_b32 s67, 0x20000
    s_mov_b32 s68, 2097152
FW_26:
    buffer_load_dword v49, v48, s[64:67], 0 offen sc0 sc1
    s_sub_u32 s68, s68, 1
    s_waitcnt vmcnt(0)
    s_cmp_eq_u32 s68, 0
    s_cbranch_scc1 FW_26x
    v_cmp_gt_u32 vcc, 0x400, v49
    s_nop 3
    s_cbranch_vccz FW_26x
    s_sleep 32
    s_branch FW_26
FW_26x:
    v_mov_b32 v48, 25664
    v_mov_b32 v49, 1
    s_mov_b64 exec, 1
    ds_add_u32 v48, v49 offset:8
    s_mov_b64 exec, -1
    s_lshl_b32 s3, s28, 8
    s_lshl_b32 s68, s61, 10
    s_add_u32 s3, s3, s68
    s_add_u32 s3, s3, 1048576
    s_add_u32 s64, s26, s3
    s_addc_u32 s65, s27, 0
    s_mov_b32 s66, 57600
    v_lshrrev_b32 v48, 2, v14
    s_mov_b32 s48, 0
    s_mov_b32 s49, 8192
    s_mov_b32 s50, 16384
    s_mov_b32 s51, 24576
    s_mov_b32 s52, 32768
    s_mov_b32 s53, 40960
    s_mov_b32 s54, 49152
    s_mov_b32 s55, 57344
    s_mov_b32 s68, 2097152
SP_27:
    buffer_load_dword v56, v48, s[64:67], s48 offen sc0 sc1
    buffer_load_dword v57, v48, s[64:67], s49 offen sc0 sc1
    buffer_load_dword v58, v48, s[64:67], s50 offen sc0 sc1
    buffer_load_dword v59, v48, s[64:67], s51 offen sc0 sc1
    buffer_load_dword v60, v48, s[64:67], s52 offen sc0 sc1
    buffer_load_dword v61, v48, s[64:67], s53 offen sc0 sc1
    buffer_load_dword v62, v48, s[64:67], s54 offen sc0 sc1
    buffer_load_dword v63, v48, s[64:67], s55 offen sc0 sc1
    s_sub_u32 s68, s68, 1
    s_waitcnt vmcnt(0)
    s_cmp_eq_u32 s68, 0
    s_cbranch_scc1 SP_27x
    v_max_u32 v51, v56, v57
    v_max_u32 v51, v51, v58
    v_max_u32 v51, v51, v59
    v_max_u32 v51, v51, v60
    v_max_u32 v51, v51, v61
    v_max_u32 v51, v51, v62
    v_max_u32 v51, v51, v63
    v_cmp_eq_u32 vcc, -1, v51
    s_nop 3
    s_cbranch_vccz SP_27x
    s_sleep 32
    s_branch SP_27
SP_27x:
    v_add_f32 v56, v56, v60
    v_add_f32 v57, v57, v61
    v_add_f32 v58, v58, v62
    v_add_f32 v59, v59, v63
    v_add_f32 v56, v56, v58
    v_add_f32 v57, v57, v59
    v_add_f32 v40, v56, v57
    s_mul_i32 s3, s28, 896
    s_lshl_b32 s68, s61, 7
    s_add_u32 s3, s3, s68
    s_add_u32 s36, s4, s3
    s_addc_u32 s37, s5, 0
    s_mov_b32 s38, 128
    v_lshrrev_b32 v48, 3, v14
    buffer_load_ushort v41, v48, s[36:39], 0 offen
    v_cvt_pk_bf16_f32 v40, v40, v40
    v_and_b32 v40, 0xffff0000, v40
    v_mul_f32 v49, 0xbfb8aa3b, v40
    v_exp_f32 v49, v49
    s_nop 0
    v_add_f32 v49, 1.0, v49
    v_rcp_f32 v49, v49
    s_nop 0
    v_mul_f32 v40, v40, v49
    v_cvt_pk_bf16_f32 v40, v40, v40
    v_and_b32 v40, 0xffff0000, v40
    s_waitcnt vmcnt(0)
    v_lshlrev_b32 v41, 16, v41
L_h_w:
    s_lshl_b32 s3, s28, 4
    s_lshl_b32 s68, s31, 1
    s_add_u32 s3, s3, s68
    s_lshl_b32 s3, s3, 11
    s_add_u32 s36, s26, s3
    s_addc_u32 s37, s27, 0
    s_mov_b32 s38, 4096
    v_mov_b32 v6, 0
    s_cmp_ge_u32 s61, 7
    s_cbranch_scc1 L_w_done
    v_mov_b32 v7, 25664
HB_28:
    s_sleep 8
    ds_read_b32 v4, v7 offset:8
    s_waitcnt lgkmcnt(0)
    v_readfirstlane_b32 s3, v4
    s_cmp_lt_u32 s3, 1
    s_cbranch_scc1 HB_28
HB_29:
    s_sleep 8
    ds_read_b32 v4, v7 offset:12
    s_waitcnt lgkmcnt(0)
    v_readfirstlane_b32 s3, v4
    s_cmp_lt_u32 s3, 1
    s_cbranch_scc1 HB_29
    s_mov_b32 s68, 2097152
L_mpoll:
    buffer_load_dwordx2 v[8:9], v6, s[36:39], 0 offen offset:1280 sc0 sc1
    buffer_load_dwordx2 v[10:11], v6, s[36:39], 0 offen offset:1408 sc0 sc1
    buffer_load_dwordx2 v[12:13], v6, s[36:39], 0 offen offset:1536 sc0 sc1
    buffer_load_dwordx2 v[14:15], v6, s[36:39], 0 offen offset:1664 sc0 sc1
    buffer_load_dwordx2 v[16:17], v6, s[36:39], 0 offen offset:3328 sc0 sc1
    buffer_load_dwordx2 v[18:19], v6, s[36:39], 0 offen offset:3456 sc0 sc1
    buffer_load_dwordx2 v[20:21], v6, s[36:39], 0 offen offset:3584 sc0 sc1
    buffer_load_dwordx2 v[22:23], v6, s[36:39], 0 offen offset:3712 sc0 sc1
    s_sub_u32 s68, s68, 1
    s_cmp_eq_u32 s68, 0
    s_cbranch_scc1 L_mpoll_x
    s_waitcnt vmcnt(0)
    v_max3_u32 v7, v8, v9, v10
    v_max3_u32 v7, v7, v11, v12
    v_max3_u32 v7, v7, v13, v14
    v_max3_u32 v7, v7, v15, v16
    v_max3_u32 v7, v7, v17, v18
    v_max3_u32 v7, v7, v19, v20
    v_max3_u32 v7, v7, v21, v22
    v_max_u32 v7, v7, v23
    v_cmp_eq_u32 vcc, -1, v7
    s_nop 3
    s_cbranch_vccz L_mpoll_x
    s_sleep 16
    s_branch L_mpoll
L_mpoll_x:
    s_waitcnt vmcnt(0)
    v_cmp_eq_u32 s[70:71], 1, v3
    v_cmp_eq_u32 s[72:73], 2, v3
    v_cmp_eq_u32 s[74:75], 3, v3
    v_max_f32 v7, v8, v10
    v_max3_f32 v7, v7, v12, v14
    v_sub_f32 v8, v8, v7
    v_sub_f32 v10, v10, v7
    v_sub_f32 v12, v12, v7
    v_sub_f32 v14, v14, v7
    v_exp_f32 v8, v8
    v_exp_f32 v10, v10
    v_exp_f32 v12, v12
    v_exp_f32 v14, v14
    s_nop 0
    v_mul_f32 v7, v8, v9
    v_fmac_f32 v7, v10, v11
    v_fmac_f32 v7, v12, v13
    v_fmac_f32 v7, v14, v15
    v_rcp_f32 v7, v7
    v_cndmask_b32 v8, v8, v10, s[70:71]
    v_cndmask_b32 v8, v8, v12, s[72:73]
    v_cndmask_b32 v8, v8, v14, s[74:75]
    v_mul_f32 v4, v7, v8
    v_max_f32 v7, v16, v18
    v_max3_f32 v7, v7, v20, v22
    v_sub_f32 v16, v16, v7
    v_sub_f32 v18, v18, v7
    v_sub_f32 v20, v20, v7
    v_sub_f32 v22, v22, v7
    v_exp_f32 v16, v16
    v_exp_f32 v18, v18
    v_exp_f32 v20, v20
    v_exp_f32 v22, v22
    s_nop 0
    v_mul_f32 v7, v16, v17
    v_fmac_f32 v7, v18, v19
    v_fmac_f32 v7, v20, v21
    v_fmac_f32 v7, v22, v23
    v_rcp_f32 v7, v7
    v_cndmask_b32 v16, v16, v18, s[70:71]
    v_cndmask_b32 v16, v16, v20, s[72:73]
    v_cndmask_b32 v16, v16, v22, s[74:75]
    v_mul_f32 v5, v7, v16
L_w_done:
    s_lshl_b32 s3, s28, 6
    s_lshl_b32 s68, s31, 3
    s_add_u32 s3, s3, s68
    s_lshl_b32 s3, s3, 11
    s_lshl_b32 s68, s60, 8
    s_add_u32 s3, s3, s68
    s_add_u32 s3, s3, 262144
    s_add_u32 s36, s26, s3
    s_addc_u32 s37, s27, 0
    s_mov_b32 s38, 16384
    s_mul_i32 s3, s28, 896
    s_lshl_b32 s68, s60, 7
    s_add_u32 s3, s3, s68
    s_add_u32 s76, s22, s3
    s_addc_u32 s77, s23, 0
    s_mov_b32 s78, 128
    s_mov_b32 s79, 0x20000
    s_movk_i32 s69, 8192
    s_mov_b32 s68, 2097152
    s_lshl_b32 s63, s31, 8
    v_lshlrev_b32 v6, 11, v3
    v_lshl_add_u32 v6, v2, 4, v6
    v_lshlrev_b32 v7, 4, v0
    v_and_b32 v1, 3, v2
    v_lshlrev_b32 v1, 9, v1
    v_lshl_add_u32 v1, v3, 4, v1
    v_lshlrev_b32 v2, 4, v2
    s_waitcnt vmcnt(0)
    s_setprio 2
    s_barrier
    s_cmp_eq_u32 s31, 7
    s_cbranch_scc1 L_y_done
    ds_read_b128 v[8:11], v1 offset:23552
    ds_read_b128 v[12:15], v1 offset:23616
    ds_read_b128 v[16:19], v1 offset:23680
    ds_read_b128 v[20:23], v1 offset:23744
    s_waitcnt lgkmcnt(3)
    v_mfma_f32_16x16x32_bf16 v[152:155], v[8:11], v[24:27], 0
    v_mfma_f32_16x16x32_bf16 v[156:159], v[8:11], v[28:31], 0
    v_mfma_f32_16x16x32_bf16 v[160:163], v[8:11], v[32:35], 0
    v_mfma_f32_16x16x32_bf16 v[164:167], v[8:11], v[36:39], 0
    ds_read_b128 v[8:11], v1 offset:23808
    s_waitcnt lgkmcnt(3)
    v_mfma_f32_16x16x32_bf16 v[152:155], v[12:15], v[40:43], v[152:155]
    v_mfma_f32_16x16x32_bf16 v[156:159], v[12:15], v[44:47], v[156:159]
    v_mfma_f32_16x16x32_bf16 v[160:163], v[12:15], v[48:51], v[160:163]
    v_mfma_f32_16x16x32_bf16 v[164:167], v[12:15], v[52:55], v[164:167]
    ds_read_b128 v[12:15], v1 offset:23872
    s_waitcnt lgkmcnt(3)
    v_mfma_f32_16x16x32_bf16 v[152:155], v[16:19], v[56:59], v[152:155]
    v_mfma_f32_16x16x32_bf16 v[156:159], v[16:19], v[60:63], v[156:159]
    v_mfma_f32_16x16x32_bf16 v[160:163], v[16:19], v[64:67], v[160:163]
    v_mfma_f32_16x16x32_bf16 v[164:167], v[16:19], v[68:71], v[164:167]
    ds_read_b128 v[16:19], v1 offset:23936
    s_waitcnt lgkmcnt(3)
    v_mfma_f32_16x16x32_bf16 v[152:155], v[20:23], v[72:75], v[152:155]
    v_mfma_f32_16x16x32_bf16 v[156:159], v[20:23], v[76:79], v[156:159]
    v_mfma_f32_16x16x32_bf16 v[160:163], v[20:23], v[80:83], v[160:163]
    v_mfma_f32_16x16x32_bf16 v[164:167], v[20:23], v[84:87], v[164:167]
    ds_read_b128 v[20:23], v1 offset:24000
    s_waitcnt lgkmcnt(3)
    v_mfma_f32_16x16x32_bf16 v[152:155], v[8:11], v[88:91], v[152:155]
    v_mfma_f32_16x16x32_bf16 v[156:159], v[8:11], v[92:95], v[156:159]
    v_mfma_f32_16x16x32_bf16 v[160:163], v[8:11], v[96:99], v[160:163]
    v_mfma_f32_16x16x32_bf16 v[164:167], v[8:11], v[100:103], v[164:167]
    s_waitcnt lgkmcnt(2)
    v_mfma_f32_16x16x32_bf16 v[152:155], v[12:15], v[104:107], v[152:155]
    v_mfma_f32_16x16x32_bf16 v[156:159], v[12:15], v[108:111], v[156:159]
    v_mfma_f32_16x16x32_bf16 v[160:163], v[12:15], v[112:115], v[160:163]
    v_mfma_f32_16x16x32_bf16 v[164:167], v[12:15], v[116:119], v[164:167]
    s_waitcnt lgkmcnt(1)
    v_mfma_f32_16x16x32_bf16 v[152:155], v[16:19], v[120:123], v[152:155]
    v_mfma_f32_16x16x32_bf16 v[156:159], v[16:19], v[124:127], v[156:159]
    v_mfma_f32_16x16x32_bf16 v[160:163], v[16:19], v[128:131], v[160:163]
    v_mfma_f32_16x16x32_bf16 v[164:167], v[16:19], v[132:135], v[164:167]
    s_waitcnt lgkmcnt(0)
    v_mfma_f32_16x16x32_bf16 v[152:155], v[20:23], v[136:139], v[152:155]
    v_mfma_f32_16x16x32_bf16 v[156:159], v[20:23], v[140:143], v[156:159]
    v_mfma_f32_16x16x32_bf16 v[160:163], v[20:23], v[144:147], v[160:163]
    v_mfma_f32_16x16x32_bf16 v[164:167], v[20:23], v[148:151], v[164:167]
    s_nop 4
    v_add_f32 v152, v152, v153
    v_add_f32 v154, v154, v155
    v_add_f32 v8, v152, v154
    v_add_f32 v156, v156, v157
    v_add_f32 v158, v158, v159
    v_add_f32 v9, v156, v158
    v_add_f32 v160, v160, v161
    v_add_f32 v162, v162, v163
    v_add_f32 v10, v160, v162
    v_add_f32 v164, v164, v165
    v_add_f32 v166, v166, v167
    v_add_f32 v11, v164, v166
    v_min_u32 v8, -2, v8
    v_min_u32 v9, -2, v9
    v_min_u32 v10, -2, v10
    v_min_u32 v11, -2, v11
    s_mov_b64 exec, 0xffff
    buffer_store_dwordx4 v[8:11], v2, s[44:47], s63 offen sc0 sc1
    s_mov_b64 exec, -1
L_y_done:
    s_cmp_ge_u32 s61, 7
    s_cbranch_scc1 L_fin
L_ypoll:
    buffer_load_dwordx4 v[48:51], v6, s[36:39], 0 offen sc0 sc1
    buffer_load_dwordx4 v[52:55], v6, s[36:39], s69 offen sc0 sc1
    s_sub_u32 s68, s68, 1
    s_cmp_eq_u32 s68, 0
    s_cbranch_scc1 L_ypoll_x
    s_waitcnt vmcnt(0)
    v_max3_u32 v1, v48, v49, v50
    v_max3_u32 v1, v1, v51, v52
    v_max3_u32 v1, v1, v53, v54
    v_max_u32 v1, v1, v55
    v_cmp_eq_u32 vcc, -1, v1
    s_nop 3
    s_cbranch_vccnz L_ypoll
L_ypoll_x:
    s_waitcnt vmcnt(0)
    v_mul_f32 v48, v4, v48
    v_mul_f32 v49, v4, v49
    v_mul_f32 v50, v4, v50
    v_mul_f32 v51, v4, v51
    v_fmac_f32 v48, v5, v52
    v_fmac_f32 v49, v5, v53
    v_fmac_f32 v50, v5, v54
    v_fmac_f32 v51, v5, v55
    ds_write_b128 v7, v[48:51] offset:25728
    s_waitcnt lgkmcnt(0)
    s_barrier
    s_cmp_lg_u32 s31, 7
    s_cbranch_scc1 L_fin
    v_and_b32 v1, 63, v0
    v_lshlrev_b32 v2, 2, v1
    ds_read_b32 v64, v2 offset:25728
    ds_read_b32 v65, v2 offset:25984
    ds_read_b32 v66, v2 offset:26240
    ds_read_b32 v67, v2 offset:26496
    ds_read_b32 v68, v2 offset:26752
    ds_read_b32 v69, v2 offset:27008
    ds_read_b32 v70, v2 offset:27264
    ds_read_b32 v71, v2 offset:27520
    ds_read_b32 v72, v2 offset:27776
    ds_read_b32 v73, v2 offset:28032
    ds_read_b32 v74, v2 offset:28288
    ds_read_b32 v75, v2 offset:28544
    ds_read_b32 v76, v2 offset:28800
    ds_read_b32 v77, v2 offset:29056
    ds_read_b32 v78, v2 offset:29312
    ds_read_b32 v79, v2 offset:29568
    ds_read_b32 v80, v2 offset:29824
    ds_read_b32 v81, v2 offset:30080
    ds_read_b32 v82, v2 offset:30336
    ds_read_b32 v83, v2 offset:30592
    ds_read_b32 v84, v2 offset:30848
    ds_read_b32 v85, v2 offset:31104
    ds_read_b32 v86, v2 offset:31360
    ds_read_b32 v87, v2 offset:31616
    ds_read_b32 v88, v2 offset:31872
    ds_read_b32 v89, v2 offset:32128
    ds_read_b32 v90, v2 offset:32384
    ds_read_b32 v91, v2 offset:32640
    ds_read_b32 v92, v2 offset:32896
    ds_read_b32 v93, v2 offset:33152
    ds_read_b32 v94, v2 offset:33408
    ds_read_b32 v95, v2 offset:33664
    s_waitcnt lgkmcnt(0)
    v_add_f32 v64, v64, v80
    v_add_f32 v65, v65, v81
    v_add_f32 v66, v66, v82
    v_add_f32 v67, v67, v83
    v_add_f32 v68, v68, v84
    v_add_f32 v69, v69, v85
    v_add_f32 v70, v70, v86
    v_add_f32 v71, v71, v87
    v_add_f32 v72, v72, v88
    v_add_f32 v73, v73, v89
    v_add_f32 v74, v74, v90
    v_add_f32 v75, v75, v91
    v_add_f32 v76, v76, v92
    v_add_f32 v77, v77, v93
    v_add_f32 v78, v78, v94
    v_add_f32 v79, v79, v95
    v_add_f32 v64, v64, v72
    v_add_f32 v65, v65, v73
    v_add_f32 v66, v66, v74
    v_add_f32 v67, v67, v75
    v_add_f32 v68, v68, v76
    v_add_f32 v69, v69, v77
    v_add_f32 v70, v70, v78
    v_add_f32 v71, v71, v79
    v_add_f32 v64, v64, v68
    v_add_f32 v65, v65, v69
    v_add_f32 v66, v66, v70
    v_add_f32 v67, v67, v71
    v_add_f32 v64, v64, v66
    v_add_f32 v65, v65, v67
    v_add_f32 v3, v64, v65
    v_cvt_pk_bf16_f32 v3, v3, v3
    v_and_b32 v3, 0xffff0000, v3
    v_mul_f32 v3, v3, v40
    v_cvt_pk_bf16_f32 v3, v3, v3
    v_and_b32 v3, 0xffff0000, v3
    v_add_f32 v3, v3, v41
    v_cvt_pk_bf16_f32 v3, v3, v3
    v_lshlrev_b32 v1, 1, v1
    buffer_store_short v3, v1, s[76:79], 0 offen
L_fin:
L_end:
    s_endpgm
.section .rodata,"a"
.p2align 6
.amdhsa_kernel recurrent_scan__mha_block_cached__glu_gated_bilinear__decode_kernel
  .amdhsa_next_free_vgpr 168
  .amdhsa_next_free_sgpr 102
  .amdhsa_accum_offset 168
  .amdhsa_group_segment_fixed_size 0
  .amdhsa_kernarg_size 96
  .amdhsa_user_sgpr_count 2
  .amdhsa_user_sgpr_kernarg_segment_ptr 1
  .amdhsa_system_sgpr_workgroup_id_x 1
  .amdhsa_float_denorm_mode_32 3
.end_amdhsa_kernel
```
